```python
import torch

def _softmax(x, axis=-1):
    return torch.softmax(x, dim=axis)
def _gelu(x):
    return torch.nn.functional.gelu(x, approximate="tanh")
def _silu(x):
    return torch.nn.functional.silu(x)
def _sigmoid(x):
    return torch.sigmoid(x)
def _layernorm(x, axis=-1, eps=1e-5):
    m = x.mean(dim=axis, keepdim=True)
    v = x.var(dim=axis, keepdim=True, unbiased=False)
    return (x - m) / torch.sqrt(v + eps)
def _scatter_add(tgt, idx, src, axis=0):
    return tgt.clone().index_add_(axis, idx, src)
def _segment_sum(src, seg, n):
    out = torch.zeros((n,) + src.shape[1:], dtype=src.dtype)
    return out.index_add_(0, seg, src)
def _pad(x, pw):
    flat = tuple(v for pair in reversed(pw) for v in pair)
    return torch.nn.functional.pad(x, flat)

kernel_name = 'recurrent_scan__ssm_conv_s4d__dense_activation_silu__prompt'

def setup_inputs():

    _w = (lambda a: (lambda t: t.to(torch.bfloat16) if t.is_floating_point() else t)(torch.as_tensor(a)))
    def _A_setup():
        Bsz, L, D, N = 1, 2048, 512, 128
        return {
            "u": _w((lambda *s: torch.randn(*s, dtype=torch.bfloat16) * 0.05)(Bsz, L, D)),
            "log_A_real": _w((lambda *s: torch.randn(*s, dtype=torch.bfloat16) * 6.4)(D, N) * 0.5),
            "A_imag": _w((lambda *s: torch.randn(*s, dtype=torch.bfloat16) * 0.2)(D, N) * 3.14),
            "C_real": _w((lambda *s: torch.randn(*s, dtype=torch.bfloat16) * 0.2)(D, N) / N ** 0.5),
            "C_imag": _w((lambda *s: torch.randn(*s, dtype=torch.bfloat16) * 0.2)(D, N) / N ** 0.5),
            "log_dt": _w((lambda *s: torch.randn(*s, dtype=torch.bfloat16) * 0.2)(D) * 0.5 - 4.0),
            "D_skip": _w((lambda *s: torch.randn(*s, dtype=torch.bfloat16) * 0.2)(D)),
        }
    _A_in = _A_setup()

    def _B_setup():
        B, S, D, F = 1, 2048, 512, 1376
        return {
            "x": _w((lambda *s: torch.randn(*s, dtype=torch.bfloat16) * 0.05)(B, S, D)),
            "w1": _w((lambda *s: torch.randn(*s, dtype=torch.bfloat16) * 0.8)(D, F) * (D ** -0.5)),
            "w2": _w((lambda *s: torch.randn(*s, dtype=torch.bfloat16) * 0.1)(F, D) * (F ** -0.5)),
        }
    _B_in = _B_setup()

    return {
        "A_u": _A_in["u"],
        "A_log_A_real": _A_in["log_A_real"],
        "A_A_imag": _A_in["A_imag"],
        "A_C_real": _A_in["C_real"],
        "A_C_imag": _A_in["C_imag"],
        "A_log_dt": _A_in["log_dt"],
        "A_D_skip": _A_in["D_skip"],
        "B_x": _B_in["x"],
        "B_w1": _B_in["w1"],
        "B_w2": _B_in["w2"],
    }

def reference(A_u, A_log_A_real, A_A_imag, A_C_real, A_C_imag, A_log_dt, A_D_skip, B_x, B_w1, B_w2):
    def _A_ref(u, log_A_real, A_imag, C_real, C_imag, log_dt, D_skip):
        L = u.shape[1]
        dt = torch.exp(log_dt)
        A = -torch.exp(log_A_real) + 1j * A_imag
        C = (C_real + 1j * C_imag) * dt[:, None]
        pos = (lambda x, dt: x.to(dt))(torch.arange(L), log_dt.dtype)
        P = torch.exp((A * dt[:, None])[:, :, None] * pos[None, None, :])
        K = 2.0 * torch.einsum("dn,dnl->dl", C, P).real
        L2 = 2 * L
        u_t = (lambda x, *d: x.permute(*d))(u, 0, 2, 1)
        Kf = (lambda x, *a, **k: torch.fft.rfft(x.float(), *a, **k))(K, L2)
        Uf = (lambda x, *a, **k: torch.fft.rfft(x.float(), *a, **k))(u_t, L2)
        y = (lambda x, *a, **k: torch.fft.irfft(x, *a, **k).to(torch.bfloat16))(Uf * Kf[None, :, :], L2)[:, :, :L]
        y = (lambda x, *d: x.permute(*d))(y, 0, 2, 1)
        return y + u * D_skip[None, None, :]

    def _B_ref(x, w1, w2):
        h = torch.einsum("bsd,df->bsf", x, w1)
        h = _silu(h)
        out = torch.einsum("bsf,fd->bsd", h, w2)
        return out

    x = A_u
    xn = _layernorm(x, axis=-1)
    s = _A_ref(xn, A_log_A_real, A_A_imag, A_C_real, A_C_imag, A_log_dt, A_D_skip)
    g = _silu(_B_ref(xn, B_w1, B_w2))
    return x + s * g
```

```asm
; @launch grid=(256,1,1) block=(256,1,1) lds=161280
.amdgcn_target "amdgcn-amd-amdhsa--gfx950"
.text
.globl recurrent_scan__ssm_conv_s4d__dense_activation_silu__prompt_kernel
.p2align 8
.type recurrent_scan__ssm_conv_s4d__dense_activation_silu__prompt_kernel,@function
recurrent_scan__ssm_conv_s4d__dense_activation_silu__prompt_kernel:
    s_cmp_ge_u32 s2, 256
    s_cbranch_scc1 L_end
    s_load_dwordx16 s[4:19], s[0:1], 0
    s_load_dwordx8 s[20:27], s[0:1], 64
    s_load_dwordx2 s[28:29], s[0:1], 96
    s_getpc_b64 s[64:65]
L_pc:
    s_lshr_b32 s72, s2, 3
    s_mul_i32 s67, s72, 1920
    v_lshlrev_b32 v74, 7, v0
    v_add_u32 v74, s67, v74
    v_mov_b32 v77, s65
    v_add_co_u32 v76, vcc, s64, v74
    s_add_u32 s64, s64, addr_table-L_pc+4096
    s_addc_u32 s65, s65, 0
    v_addc_co_u32 v77, vcc, 0, v77, vcc
    v_lshlrev_b32 v75, 4, v0
    v_mov_b32 v57, s65
    v_add_co_u32 v56, vcc, s64, v75
    s_and_b32 s96, s2, 7
    s_and_b32 s66, s72, 3
    v_addc_co_u32 v57, vcc, 0, v57, vcc
    s_and_b32 s57, s96, 1
    s_lshl_b32 s57, s57, 2
    s_add_u32 s57, s57, s66
    s_cmp_lt_u32 s57, 6
    s_cselect_b32 s67, 0, 36864
    global_load_dwordx4 v[16:19], v[56:57], off offset:-4096
    v_add_co_u32 v78, vcc, s67, v56
    s_nop 1
    v_addc_co_u32 v79, vcc, 0, v57, vcc
    v_add_co_u32 v80, vcc, 8192, v56
    s_nop 1
    v_addc_co_u32 v81, vcc, 0, v57, vcc
    global_load_dwordx4 v[20:23], v[78:79], off
    global_load_dwordx4 v[24:27], v[80:81], off offset:-4096
    global_load_dwordx4 v[28:31], v[80:81], off
    v_cmp_gt_u32 vcc, 15, v0
    v_and_b32 v1, 63, v0
    v_lshrrev_b32 v4, 6, v0
    s_and_saveexec_b64 s[90:91], vcc
    s_cbranch_execz L_nocpf
    global_load_dword v237, v[76:77], off
L_nocpf:
    s_mov_b64 exec, s[90:91]
    v_readfirstlane_b32 s61, v4
    v_lshlrev_b32 v7, 4, v1
    s_lshr_b32 s65, s72, 2
    s_lshr_b32 s56, s96, 1
    s_lshl_b32 s56, s56, 3
    s_add_u32 s56, s56, s65
    s_lshl_b32 s60, s57, 5
    s_add_u32 s60, s60, s56
    s_lshl_b32 s67, s60, 9
    v_lshlrev_b32 v68, 1, v0
    v_add_u32 v68, s67, v68
    v_mov_b32 v72, 1073741824
    v_lshlrev_b32 v70, 7, v0
    v_cmp_gt_u32 vcc, 128, v0
    s_lshl_b32 s64, s56, 16
    s_lshl_b32 s66, s66, 14
    s_add_u32 s66, s66, s64
    v_cndmask_b32 v73, v72, v70, vcc
    s_lshl_b32 s65, s61, 14
    s_add_u32 s92, s64, s65
    s_mul_i32 s93, s61, 16896
    s_add_u32 s93, s93, 83968
    s_lshl_b32 s67, s60, 2
    s_waitcnt lgkmcnt(0)
    global_load_ushort v64, v68, s[6:7]
    global_load_ushort v65, v68, s[8:9]
    global_load_ushort v66, v68, s[10:11]
    global_load_ushort v67, v68, s[12:13]
    s_mov_b32 s32, s4
    s_and_b32 s33, s5, 0xffff
    s_mov_b32 s34, 2097152
    s_mov_b32 s35, 0x00020000
    buffer_load_dword v239, v73, s[32:35], s66 offen
    s_load_dword s30, s[14:15], s67
    s_load_dword s31, s[16:17], s67
    s_add_u32 s66, s28, 10551296
    s_addc_u32 s67, s29, 0
    s_load_dword s62, s[66:67], 0
    s_add_u32 m0, s93, 0
    s_add_u32 s94, s92, 0
    buffer_load_dwordx4 v7, s[32:35], s94 offen lds
    s_add_u32 m0, s93, 1056
    s_add_u32 s94, s92, 1024
    buffer_load_dwordx4 v7, s[32:35], s94 offen lds
    s_mul_i32 s70, s57, 11
    s_cmp_eq_u32 s57, 7
    s_cselect_b32 s64, 1, 0
    s_sub_u32 s70, s70, s64
    s_lshl_b32 s64, s70, 5
    s_add_u32 s36, s20, s64
    s_addc_u32 s37, s21, 0
    s_and_b32 s37, s37, 0xffff
    s_add_u32 m0, s93, 2112
    s_add_u32 s94, s92, 2048
    buffer_load_dwordx4 v7, s[32:35], s94 offen lds
    s_sub_u32 s38, 1409024, s64
    s_mov_b32 s39, 0x00020000
    v_lshrrev_b32 v70, 4, v0
    v_mul_u32_u24 v70, 2752, v70
    v_and_b32 v71, 15, v0
    v_lshl_add_u32 v70, v71, 7, v70
    v_cmp_gt_u32 vcc, 12, v71
    s_mul_i32 s65, s72, 44032
    s_add_u32 m0, s93, 3168
    s_add_u32 s94, s92, 3072
    buffer_load_dwordx4 v7, s[32:35], s94 offen lds
    s_sub_u32 s65, s65, s64
    s_lshr_b32 s64, s57, 2
    s_mul_i32 s64, s64, 1408
    s_add_u32 s65, s65, s64
    v_cndmask_b32 v59, v72, v70, vcc
    v_cmp_gt_u32 vcc, 256, v0
    s_add_u32 s97, s65, 704512
    s_nop 0
    v_cndmask_b32 v59, v72, v59, vcc
    s_add_u32 m0, s93, 4224
    s_add_u32 s94, s92, 4096
    buffer_load_dwordx4 v7, s[32:35], s94 offen lds
    buffer_load_dword v238, v59, s[36:39], s65 offen
    s_mov_b32 s48, s28
    s_and_b32 s49, s29, 0xffff
    s_mov_b32 s50, 268435456
    s_mov_b32 s51, 0x00020000
    s_mov_b32 s44, s24
    s_and_b32 s45, s25, 0xffff
    s_mov_b32 s46, 2097152
    s_mov_b32 s47, 0x00020000
    s_lshl_b32 s64, s57, 7
    s_add_u32 s40, s22, s64
    s_addc_u32 s41, s23, 0
    s_and_b32 s41, s41, 0xffff
    s_sub_u32 s42, 1409024, s64
    s_mov_b32 s43, 0x00020000
    s_lshl_b32 s65, s56, 16
    s_add_u32 s58, s65, s64
    s_lshr_b32 s82, s61, 1
    s_and_b32 s83, s61, 1
    s_xor_b32 s95, s83, s82
    s_mov_b32 s80, 1069066811
    s_mov_b32 s81, 3216550459
    s_mul_i32 s73, s61, 20992
    s_mul_i32 s75, s82, 8704
    s_add_u32 s75, s75, 83968
    s_lshl_b32 s74, s61, 13
    s_add_u32 s74, s74, 117760
    v_add_u32 v4, s73, v7
    s_mul_i32 s64, s61, 3
    s_add_u32 s70, s70, s64
    s_cmp_lt_u32 s57, 6
    s_cselect_b32 s71, 11, 10
    s_sub_u32 s71, s71, s64
    s_lshl_b32 s64, s57, 18
    s_lshl_b32 s65, s56, 7
    s_add_u32 s78, s64, s65
    s_add_u32 m0, s93, 5280
    s_add_u32 s94, s92, 5120
    buffer_load_dwordx4 v7, s[32:35], s94 offen lds
    s_add_u32 s78, s78, 2097152
    s_lshl_b32 s76, s60, 13
    s_add_u32 s76, s76, 2097152
    s_mul_i32 s59, s56, 176128
    s_add_u32 s59, s59, 4194304
    s_lshl_b32 s64, s57, 2
    s_add_u32 s64, s64, s61
    s_lshl_b32 s68, s64, 2
    s_add_u32 s68, s68, s65
    s_add_u32 s68, s68, 10493952
    s_lshl_b32 s64, s64, 7
    s_lshl_b32 s69, s56, 2
    s_add_u32 s69, s69, s64
    s_add_u32 s69, s69, 10485760
    s_lshl_b32 s99, s61, 5
    s_add_u32 s99, s99, s65
    s_add_u32 s99, s99, 10493952
    s_lshl_b32 s64, s57, 2
    s_lshr_b32 s65, s56, 3
    s_add_u32 s64, s64, s65
    s_lshl_b32 s64, s64, 7
    s_add_u32 s98, s64, 10485760
    s_mov_b32 s84, 0x00f0000f
    s_mov_b32 s85, 0xf0000f00
    s_mov_b32 s86, 0x22222222
    s_mov_b32 s87, 0x22222222
    s_mov_b32 s88, 0x44444444
    s_mov_b32 s89, 0x44444444
    s_mov_b32 s90, 0x88888888
    s_mov_b32 s91, 0x88888888
    v_mov_b32 v5, 0
    v_mov_b32 v60, -1
    v_mov_b32 v61, -1
    v_mov_b32 v62, -1
    v_mov_b32 v63, -1
    s_add_u32 m0, s93, 6336
    s_add_u32 s94, s92, 6144
    buffer_load_dwordx4 v7, s[32:35], s94 offen lds
    s_mov_b32 s65, 849703008
    s_mov_b32 s66, 1060205080
    s_waitcnt lgkmcnt(0)
    s_add_u32 s79, s62, 1
    s_xor_b32 s62, s79, 0x9e3779b9
    s_mov_b32 s63, s62
    s_lshl_b32 s64, s82, 4
    s_lshr_b32 s30, s30, s64
    s_lshl_b32 s30, s30, 16
    s_lshr_b32 s31, s31, s64
    s_lshl_b32 s31, s31, 16
    v_mov_b32 v6, s62
    v_mov_b32 v92, s30
    v_mul_f32 v94, s80, v92
    v_fma_f32 v95, v92, s80, -v94
    v_fmac_f32 v95, s65, v92
    v_exp_f32 v96, v94
    v_mul_f32 v95, s66, v95
    v_fmac_f32 v96, v96, v95
    v_cvt_pk_bf16_f32 v96, v96, v96
    v_and_b32 v96, 0xffff0000, v96
    s_waitcnt vmcnt(9)
    s_add_u32 s64, s78, 32768
    buffer_store_dwordx4 v[60:63], v19, s[48:51], s78 offen sc1
    buffer_store_dwordx4 v[60:63], v19, s[48:51], s64 offen sc1
    v_lshlrev_b32 v64, 16, v64
    v_lshlrev_b32 v65, 16, v65
    v_lshlrev_b32 v66, 16, v66
    v_lshlrev_b32 v67, 16, v67
    v_mul_f32 v94, s80, v64
    v_fma_f32 v95, v64, s80, -v94
    v_fmac_f32 v95, s65, v64
    v_exp_f32 v92, v94
    v_mul_f32 v95, s66, v95
    v_fmac_f32 v92, v92, v95
    v_cvt_pk_bf16_f32 v92, v92, v92
    v_and_b32 v92, 0xffff0000, v92
    v_mul_f32 v92, v92, v96
    v_mul_f32 v93, v65, v96
    v_mul_f32 v78, v66, v96
    v_mul_f32 v79, v67, v96
    v_mul_f32 v92, s81, v92
    v_mul_f32 v93, 0.15915494, v93
    v_add_f32 v78, v78, v78
    v_add_f32 v79, v79, v79
    v_mul_f32 v94, 8.0, v92
    v_mul_f32 v95, 8.0, v93
    v_exp_f32 v94, v94
    v_fract_f32 v95, v95
    v_cos_f32 v74, v95
    v_sin_f32 v75, v95
    s_nop 0
    v_pk_mul_f32 v[74:75], v[74:75], v[94:95] op_sel:[0,0] op_sel_hi:[1,0]
    v_exp_f32 v94, v92
    v_fract_f32 v95, v93
    v_cos_f32 v68, v95
    v_sin_f32 v69, v95
    s_nop 0
    v_pk_mul_f32 v[68:69], v[68:69], v[94:95] op_sel:[0,0] op_sel_hi:[1,0]
    v_mul_f32 v94, 256.0, v92
    v_mul_f32 v95, 256.0, v93
    v_exp_f32 v94, v94
    v_fract_f32 v95, v95
    v_cos_f32 v76, v95
    v_sin_f32 v77, v95
    s_nop 0
    v_pk_mul_f32 v[76:77], v[76:77], v[94:95] op_sel:[0,0] op_sel_hi:[1,0]
    v_mov_b32 v91, 0x3f80
    ds_write_b32 v16, v91 offset:0
    v_cvt_pk_bf16_f32 v88, v74, v75
    ds_write_b32 v16, v88 offset:272
    v_pk_mul_f32 v[80:81], v[74:75], v[74:75] op_sel:[0,0] op_sel_hi:[0,1]
    v_pk_fma_f32 v[80:81], v[74:75], v[74:75], v[80:81] op_sel:[1,1,0] op_sel_hi:[1,0,1] neg_lo:[0,1,0]
    v_cvt_pk_bf16_f32 v89, v80, v81
    ds_write_b32 v16, v89 offset:544
    v_pk_mul_f32 v[82:83], v[80:81], v[74:75] op_sel:[0,0] op_sel_hi:[0,1]
    v_pk_fma_f32 v[82:83], v[80:81], v[74:75], v[82:83] op_sel:[1,1,0] op_sel_hi:[1,0,1] neg_lo:[0,1,0]
    v_cvt_pk_bf16_f32 v90, v82, v83
    ds_write_b32 v16, v90 offset:816
    v_pk_mul_f32 v[80:81], v[82:83], v[74:75] op_sel:[0,0] op_sel_hi:[0,1]
    v_pk_fma_f32 v[80:81], v[82:83], v[74:75], v[80:81] op_sel:[1,1,0] op_sel_hi:[1,0,1] neg_lo:[0,1,0]
    v_cvt_pk_bf16_f32 v91, v80, v81
    ds_write_b32 v16, v91 offset:1088
    v_pk_mul_f32 v[70:71], v[68:69], v[68:69] op_sel:[0,0] op_sel_hi:[0,1]
    v_pk_fma_f32 v[70:71], v[68:69], v[68:69], v[70:71] op_sel:[1,1,0] op_sel_hi:[1,0,1] neg_lo:[0,1,0]
    v_pk_mul_f32 v[82:83], v[80:81], v[74:75] op_sel:[0,0] op_sel_hi:[0,1]
    v_pk_fma_f32 v[82:83], v[80:81], v[74:75], v[82:83] op_sel:[1,1,0] op_sel_hi:[1,0,1] neg_lo:[0,1,0]
    v_cvt_pk_bf16_f32 v88, v82, v83
    ds_write_b32 v16, v88 offset:1360
    v_pk_mul_f32 v[80:81], v[82:83], v[74:75] op_sel:[0,0] op_sel_hi:[0,1]
    v_pk_fma_f32 v[80:81], v[82:83], v[74:75], v[80:81] op_sel:[1,1,0] op_sel_hi:[1,0,1] neg_lo:[0,1,0]
    v_cvt_pk_bf16_f32 v89, v80, v81
    ds_write_b32 v16, v89 offset:1632
    v_pk_mul_f32 v[72:73], v[70:71], v[70:71] op_sel:[0,0] op_sel_hi:[0,1]
    v_pk_fma_f32 v[72:73], v[70:71], v[70:71], v[72:73] op_sel:[1,1,0] op_sel_hi:[1,0,1] neg_lo:[0,1,0]
    v_pk_mul_f32 v[82:83], v[80:81], v[74:75] op_sel:[0,0] op_sel_hi:[0,1]
    v_pk_fma_f32 v[82:83], v[80:81], v[74:75], v[82:83] op_sel:[1,1,0] op_sel_hi:[1,0,1] neg_lo:[0,1,0]
    v_cvt_pk_bf16_f32 v90, v82, v83
    ds_write_b32 v16, v90 offset:1904
    v_pk_mul_f32 v[80:81], v[82:83], v[74:75] op_sel:[0,0] op_sel_hi:[0,1]
    v_pk_fma_f32 v[80:81], v[82:83], v[74:75], v[80:81] op_sel:[1,1,0] op_sel_hi:[1,0,1] neg_lo:[0,1,0]
    v_cvt_pk_bf16_f32 v91, v80, v81
    ds_write_b32 v16, v91 offset:2176
    v_pk_mul_f32 v[82:83], v[80:81], v[74:75] op_sel:[0,0] op_sel_hi:[0,1]
    v_pk_fma_f32 v[82:83], v[80:81], v[74:75], v[82:83] op_sel:[1,1,0] op_sel_hi:[1,0,1] neg_lo:[0,1,0]
    v_cvt_pk_bf16_f32 v88, v82, v83
    ds_write_b32 v16, v88 offset:2448
    v_pk_mul_f32 v[80:81], v[82:83], v[74:75] op_sel:[0,0] op_sel_hi:[0,1]
    v_pk_fma_f32 v[80:81], v[82:83], v[74:75], v[80:81] op_sel:[1,1,0] op_sel_hi:[1,0,1] neg_lo:[0,1,0]
    v_cvt_pk_bf16_f32 v89, v80, v81
    ds_write_b32 v16, v89 offset:2720
    v_pk_mul_f32 v[82:83], v[80:81], v[74:75] op_sel:[0,0] op_sel_hi:[0,1]
    v_pk_fma_f32 v[82:83], v[80:81], v[74:75], v[82:83] op_sel:[1,1,0] op_sel_hi:[1,0,1] neg_lo:[0,1,0]
    v_cvt_pk_bf16_f32 v90, v82, v83
    ds_write_b32 v16, v90 offset:2992
    v_pk_mul_f32 v[80:81], v[82:83], v[74:75] op_sel:[0,0] op_sel_hi:[0,1]
    v_pk_fma_f32 v[80:81], v[82:83], v[74:75], v[80:81] op_sel:[1,1,0] op_sel_hi:[1,0,1] neg_lo:[0,1,0]
    v_cvt_pk_bf16_f32 v91, v80, v81
    ds_write_b32 v16, v91 offset:3264
    v_pk_mul_f32 v[82:83], v[80:81], v[74:75] op_sel:[0,0] op_sel_hi:[0,1]
    v_pk_fma_f32 v[82:83], v[80:81], v[74:75], v[82:83] op_sel:[1,1,0] op_sel_hi:[1,0,1] neg_lo:[0,1,0]
    v_cvt_pk_bf16_f32 v88, v82, v83
    ds_write_b32 v16, v88 offset:3536
    v_pk_mul_f32 v[80:81], v[82:83], v[74:75] op_sel:[0,0] op_sel_hi:[0,1]
    v_pk_fma_f32 v[80:81], v[82:83], v[74:75], v[80:81] op_sel:[1,1,0] op_sel_hi:[1,0,1] neg_lo:[0,1,0]
    v_cvt_pk_bf16_f32 v89, v80, v81
    ds_write_b32 v16, v89 offset:3808
    v_pk_mul_f32 v[82:83], v[80:81], v[74:75] op_sel:[0,0] op_sel_hi:[0,1]
    v_pk_fma_f32 v[82:83], v[80:81], v[74:75], v[82:83] op_sel:[1,1,0] op_sel_hi:[1,0,1] neg_lo:[0,1,0]
    v_cvt_pk_bf16_f32 v90, v82, v83
    ds_write_b32 v16, v90 offset:4080
    v_pk_mul_f32 v[80:81], v[82:83], v[74:75] op_sel:[0,0] op_sel_hi:[0,1]
    v_pk_fma_f32 v[80:81], v[82:83], v[74:75], v[80:81] op_sel:[1,1,0] op_sel_hi:[1,0,1] neg_lo:[0,1,0]
    v_cvt_pk_bf16_f32 v91, v80, v81
    ds_write_b32 v16, v91 offset:4352
    v_pk_mul_f32 v[82:83], v[80:81], v[74:75] op_sel:[0,0] op_sel_hi:[0,1]
    v_pk_fma_f32 v[82:83], v[80:81], v[74:75], v[82:83] op_sel:[1,1,0] op_sel_hi:[1,0,1] neg_lo:[0,1,0]
    v_cvt_pk_bf16_f32 v88, v82, v83
    ds_write_b32 v16, v88 offset:4624
    v_pk_mul_f32 v[80:81], v[82:83], v[74:75] op_sel:[0,0] op_sel_hi:[0,1]
    v_pk_fma_f32 v[80:81], v[82:83], v[74:75], v[80:81] op_sel:[1,1,0] op_sel_hi:[1,0,1] neg_lo:[0,1,0]
    v_cvt_pk_bf16_f32 v89, v80, v81
    ds_write_b32 v16, v89 offset:4896
    v_pk_mul_f32 v[82:83], v[80:81], v[74:75] op_sel:[0,0] op_sel_hi:[0,1]
    v_pk_fma_f32 v[82:83], v[80:81], v[74:75], v[82:83] op_sel:[1,1,0] op_sel_hi:[1,0,1] neg_lo:[0,1,0]
    v_cvt_pk_bf16_f32 v90, v82, v83
    ds_write_b32 v16, v90 offset:5168
    v_pk_mul_f32 v[80:81], v[82:83], v[74:75] op_sel:[0,0] op_sel_hi:[0,1]
    v_pk_fma_f32 v[80:81], v[82:83], v[74:75], v[80:81] op_sel:[1,1,0] op_sel_hi:[1,0,1] neg_lo:[0,1,0]
    v_cvt_pk_bf16_f32 v91, v80, v81
    ds_write_b32 v16, v91 offset:5440
    v_pk_mul_f32 v[82:83], v[80:81], v[74:75] op_sel:[0,0] op_sel_hi:[0,1]
    v_pk_fma_f32 v[82:83], v[80:81], v[74:75], v[82:83] op_sel:[1,1,0] op_sel_hi:[1,0,1] neg_lo:[0,1,0]
    v_cvt_pk_bf16_f32 v88, v82, v83
    ds_write_b32 v16, v88 offset:5712
    v_pk_mul_f32 v[80:81], v[82:83], v[74:75] op_sel:[0,0] op_sel_hi:[0,1]
    v_pk_fma_f32 v[80:81], v[82:83], v[74:75], v[80:81] op_sel:[1,1,0] op_sel_hi:[1,0,1] neg_lo:[0,1,0]
    v_cvt_pk_bf16_f32 v89, v80, v81
    ds_write_b32 v16, v89 offset:5984
    v_pk_mul_f32 v[82:83], v[80:81], v[74:75] op_sel:[0,0] op_sel_hi:[0,1]
    v_pk_fma_f32 v[82:83], v[80:81], v[74:75], v[82:83] op_sel:[1,1,0] op_sel_hi:[1,0,1] neg_lo:[0,1,0]
    v_cvt_pk_bf16_f32 v90, v82, v83
    ds_write_b32 v16, v90 offset:6256
    v_pk_mul_f32 v[80:81], v[82:83], v[74:75] op_sel:[0,0] op_sel_hi:[0,1]
    v_pk_fma_f32 v[80:81], v[82:83], v[74:75], v[80:81] op_sel:[1,1,0] op_sel_hi:[1,0,1] neg_lo:[0,1,0]
    v_cvt_pk_bf16_f32 v91, v80, v81
    ds_write_b32 v16, v91 offset:6528
    v_pk_mul_f32 v[82:83], v[80:81], v[74:75] op_sel:[0,0] op_sel_hi:[0,1]
    v_pk_fma_f32 v[82:83], v[80:81], v[74:75], v[82:83] op_sel:[1,1,0] op_sel_hi:[1,0,1] neg_lo:[0,1,0]
    v_cvt_pk_bf16_f32 v88, v82, v83
    ds_write_b32 v16, v88 offset:6800
    v_pk_mul_f32 v[80:81], v[82:83], v[74:75] op_sel:[0,0] op_sel_hi:[0,1]
    v_pk_fma_f32 v[80:81], v[82:83], v[74:75], v[80:81] op_sel:[1,1,0] op_sel_hi:[1,0,1] neg_lo:[0,1,0]
    v_cvt_pk_bf16_f32 v89, v80, v81
    ds_write_b32 v16, v89 offset:7072
    v_pk_mul_f32 v[82:83], v[80:81], v[74:75] op_sel:[0,0] op_sel_hi:[0,1]
    v_pk_fma_f32 v[82:83], v[80:81], v[74:75], v[82:83] op_sel:[1,1,0] op_sel_hi:[1,0,1] neg_lo:[0,1,0]
    v_cvt_pk_bf16_f32 v90, v82, v83
    ds_write_b32 v16, v90 offset:7344
    v_pk_mul_f32 v[80:81], v[82:83], v[74:75] op_sel:[0,0] op_sel_hi:[0,1]
    v_pk_fma_f32 v[80:81], v[82:83], v[74:75], v[80:81] op_sel:[1,1,0] op_sel_hi:[1,0,1] neg_lo:[0,1,0]
    v_cvt_pk_bf16_f32 v91, v80, v81
    ds_write_b32 v16, v91 offset:7616
    v_pk_mul_f32 v[82:83], v[80:81], v[74:75] op_sel:[0,0] op_sel_hi:[0,1]
    v_pk_fma_f32 v[82:83], v[80:81], v[74:75], v[82:83] op_sel:[1,1,0] op_sel_hi:[1,0,1] neg_lo:[0,1,0]
    v_cvt_pk_bf16_f32 v88, v82, v83
    ds_write_b32 v16, v88 offset:7888
    v_pk_mul_f32 v[80:81], v[82:83], v[74:75] op_sel:[0,0] op_sel_hi:[0,1]
    v_pk_fma_f32 v[80:81], v[82:83], v[74:75], v[80:81] op_sel:[1,1,0] op_sel_hi:[1,0,1] neg_lo:[0,1,0]
    v_cvt_pk_bf16_f32 v89, v80, v81
    ds_write_b32 v16, v89 offset:8160
    v_pk_mul_f32 v[82:83], v[80:81], v[74:75] op_sel:[0,0] op_sel_hi:[0,1]
    v_pk_fma_f32 v[82:83], v[80:81], v[74:75], v[82:83] op_sel:[1,1,0] op_sel_hi:[1,0,1] neg_lo:[0,1,0]
    v_cvt_pk_bf16_f32 v90, v82, v83
    ds_write_b32 v16, v90 offset:8432
    ds_read_b128 v[100:103], v17 offset:0
    ds_read_b128 v[104:107], v17 offset:32
    ds_read_b128 v[108:111], v17 offset:64
    ds_read_b128 v[112:115], v17 offset:96
    ds_read_b128 v[116:119], v17 offset:128
    ds_read_b128 v[120:123], v17 offset:160
    ds_read_b128 v[124:127], v17 offset:192
    ds_read_b128 v[128:131], v17 offset:224
    v_cvt_pk_bf16_f32 v91, v78, -v79
    ds_write_b32 v16, v91 offset:2992
    v_pk_mul_f32 v[82:83], v[78:79], v[68:69] op_sel:[0,0] op_sel_hi:[0,1]
    v_pk_fma_f32 v[82:83], v[78:79], v[68:69], v[82:83] op_sel:[1,1,0] op_sel_hi:[1,0,1] neg_lo:[0,1,0]
    v_cvt_pk_bf16_f32 v88, v82, -v83
    ds_write_b32 v16, v88 offset:4352
    v_pk_mul_f32 v[80:81], v[82:83], v[68:69] op_sel:[0,0] op_sel_hi:[0,1]
    v_pk_fma_f32 v[80:81], v[82:83], v[68:69], v[80:81] op_sel:[1,1,0] op_sel_hi:[1,0,1] neg_lo:[0,1,0]
    v_cvt_pk_bf16_f32 v89, v80, -v81
    ds_write_b32 v16, v89 offset:4624
    v_pk_mul_f32 v[82:83], v[80:81], v[68:69] op_sel:[0,0] op_sel_hi:[0,1]
    v_pk_fma_f32 v[82:83], v[80:81], v[68:69], v[82:83] op_sel:[1,1,0] op_sel_hi:[1,0,1] neg_lo:[0,1,0]
    v_cvt_pk_bf16_f32 v90, v82, -v83
    ds_write_b32 v16, v90 offset:4896
    v_pk_mul_f32 v[80:81], v[82:83], v[68:69] op_sel:[0,0] op_sel_hi:[0,1]
    v_pk_fma_f32 v[80:81], v[82:83], v[68:69], v[80:81] op_sel:[1,1,0] op_sel_hi:[1,0,1] neg_lo:[0,1,0]
    v_cvt_pk_bf16_f32 v91, v80, -v81
    ds_write_b32 v16, v91 offset:5168
    v_pk_mul_f32 v[82:83], v[80:81], v[68:69] op_sel:[0,0] op_sel_hi:[0,1]
    v_pk_fma_f32 v[82:83], v[80:81], v[68:69], v[82:83] op_sel:[1,1,0] op_sel_hi:[1,0,1] neg_lo:[0,1,0]
    v_cvt_pk_bf16_f32 v88, v82, -v83
    ds_write_b32 v16, v88 offset:6528
    v_pk_mul_f32 v[80:81], v[82:83], v[68:69] op_sel:[0,0] op_sel_hi:[0,1]
    v_pk_fma_f32 v[80:81], v[82:83], v[68:69], v[80:81] op_sel:[1,1,0] op_sel_hi:[1,0,1] neg_lo:[0,1,0]
    v_cvt_pk_bf16_f32 v89, v80, -v81
    ds_write_b32 v16, v89 offset:6800
    v_pk_mul_f32 v[82:83], v[80:81], v[68:69] op_sel:[0,0] op_sel_hi:[0,1]
    v_pk_fma_f32 v[82:83], v[80:81], v[68:69], v[82:83] op_sel:[1,1,0] op_sel_hi:[1,0,1] neg_lo:[0,1,0]
    v_cvt_pk_bf16_f32 v90, v82, -v83
    ds_write_b32 v16, v90 offset:7072
    v_pk_mul_f32 v[80:81], v[82:83], v[68:69] op_sel:[0,0] op_sel_hi:[0,1]
    v_pk_fma_f32 v[80:81], v[82:83], v[68:69], v[80:81] op_sel:[1,1,0] op_sel_hi:[1,0,1] neg_lo:[0,1,0]
    v_cvt_pk_bf16_f32 v91, v80, -v81
    ds_write_b32 v16, v91 offset:7344
    v_pk_mul_f32 v[84:85], v[78:79], v[76:77] op_sel:[0,0] op_sel_hi:[0,1]
    v_pk_fma_f32 v[84:85], v[78:79], v[76:77], v[84:85] op_sel:[1,1,0] op_sel_hi:[1,0,1] neg_lo:[0,1,0]
    v_cvt_pk_bf16_f32 v88, v84, -v85
    ds_write_b32 v16, v88 offset:4080
    v_pk_mul_f32 v[82:83], v[84:85], v[70:71] op_sel:[0,0] op_sel_hi:[0,1]
    v_pk_fma_f32 v[82:83], v[84:85], v[70:71], v[82:83] op_sel:[1,1,0] op_sel_hi:[1,0,1] neg_lo:[0,1,0]
    v_cvt_pk_bf16_f32 v89, v82, -v83
    ds_write_b32 v16, v89 offset:5440
    v_pk_mul_f32 v[80:81], v[82:83], v[70:71] op_sel:[0,0] op_sel_hi:[0,1]
    v_pk_fma_f32 v[80:81], v[82:83], v[70:71], v[80:81] op_sel:[1,1,0] op_sel_hi:[1,0,1] neg_lo:[0,1,0]
    v_cvt_pk_bf16_f32 v90, v80, -v81
    ds_write_b32 v16, v90 offset:5712
    v_pk_mul_f32 v[82:83], v[80:81], v[70:71] op_sel:[0,0] op_sel_hi:[0,1]
    v_pk_fma_f32 v[82:83], v[80:81], v[70:71], v[82:83] op_sel:[1,1,0] op_sel_hi:[1,0,1] neg_lo:[0,1,0]
    v_cvt_pk_bf16_f32 v91, v82, -v83
    ds_write_b32 v16, v91 offset:5984
    v_pk_mul_f32 v[80:81], v[82:83], v[70:71] op_sel:[0,0] op_sel_hi:[0,1]
    v_pk_fma_f32 v[80:81], v[82:83], v[70:71], v[80:81] op_sel:[1,1,0] op_sel_hi:[1,0,1] neg_lo:[0,1,0]
    v_cvt_pk_bf16_f32 v88, v80, -v81
    ds_write_b32 v16, v88 offset:6256
    v_pk_mul_f32 v[86:87], v[84:85], v[76:77] op_sel:[0,0] op_sel_hi:[0,1]
    v_pk_fma_f32 v[86:87], v[84:85], v[76:77], v[86:87] op_sel:[1,1,0] op_sel_hi:[1,0,1] neg_lo:[0,1,0]
    v_cvt_pk_bf16_f32 v89, v86, -v87
    ds_write_b32 v16, v89 offset:2176
    v_pk_mul_f32 v[80:81], v[86:87], v[72:73] op_sel:[0,0] op_sel_hi:[0,1]
    v_pk_fma_f32 v[80:81], v[86:87], v[72:73], v[80:81] op_sel:[1,1,0] op_sel_hi:[1,0,1] neg_lo:[0,1,0]
    v_cvt_pk_bf16_f32 v90, v80, -v81
    ds_write_b32 v16, v90 offset:2448
    v_pk_mul_f32 v[82:83], v[86:87], v[74:75] op_sel:[0,0] op_sel_hi:[0,1]
    v_pk_fma_f32 v[82:83], v[86:87], v[74:75], v[82:83] op_sel:[1,1,0] op_sel_hi:[1,0,1] neg_lo:[0,1,0]
    v_cvt_pk_bf16_f32 v91, v82, -v83
    ds_write_b32 v16, v91 offset:2720
    v_pk_mul_f32 v[84:85], v[86:87], v[76:77] op_sel:[0,0] op_sel_hi:[0,1]
    v_pk_fma_f32 v[84:85], v[86:87], v[76:77], v[84:85] op_sel:[1,1,0] op_sel_hi:[1,0,1] neg_lo:[0,1,0]
    v_cvt_pk_bf16_f32 v88, v84, -v85
    ds_write_b32 v16, v88 offset:3264
    v_pk_mul_f32 v[80:81], v[84:85], v[72:73] op_sel:[0,0] op_sel_hi:[0,1]
    v_pk_fma_f32 v[80:81], v[84:85], v[72:73], v[80:81] op_sel:[1,1,0] op_sel_hi:[1,0,1] neg_lo:[0,1,0]
    v_cvt_pk_bf16_f32 v89, v80, -v81
    ds_write_b32 v16, v89 offset:3536
    v_pk_mul_f32 v[82:83], v[84:85], v[74:75] op_sel:[0,0] op_sel_hi:[0,1]
    v_pk_fma_f32 v[82:83], v[84:85], v[74:75], v[82:83] op_sel:[1,1,0] op_sel_hi:[1,0,1] neg_lo:[0,1,0]
    v_cvt_pk_bf16_f32 v90, v82, -v83
    ds_write_b32 v16, v90 offset:3808
    v_pk_mul_f32 v[86:87], v[84:85], v[76:77] op_sel:[0,0] op_sel_hi:[0,1]
    v_pk_fma_f32 v[86:87], v[84:85], v[76:77], v[86:87] op_sel:[1,1,0] op_sel_hi:[1,0,1] neg_lo:[0,1,0]
    v_cvt_pk_bf16_f32 v91, v86, -v87
    ds_write_b32 v16, v91 offset:0
    v_pk_mul_f32 v[80:81], v[86:87], v[74:75] op_sel:[0,0] op_sel_hi:[0,1]
    v_pk_fma_f32 v[80:81], v[86:87], v[74:75], v[80:81] op_sel:[1,1,0] op_sel_hi:[1,0,1] neg_lo:[0,1,0]
    v_cvt_pk_bf16_f32 v88, v80, -v81
    ds_write_b32 v16, v88 offset:272
    v_pk_mul_f32 v[84:85], v[86:87], v[76:77] op_sel:[0,0] op_sel_hi:[0,1]
    v_pk_fma_f32 v[84:85], v[86:87], v[76:77], v[84:85] op_sel:[1,1,0] op_sel_hi:[1,0,1] neg_lo:[0,1,0]
    v_cvt_pk_bf16_f32 v89, v84, -v85
    ds_write_b32 v16, v89 offset:544
    v_pk_mul_f32 v[82:83], v[84:85], v[74:75] op_sel:[0,0] op_sel_hi:[0,1]
    v_pk_fma_f32 v[82:83], v[84:85], v[74:75], v[82:83] op_sel:[1,1,0] op_sel_hi:[1,0,1] neg_lo:[0,1,0]
    v_cvt_pk_bf16_f32 v90, v82, -v83
    ds_write_b32 v16, v90 offset:816
    v_pk_mul_f32 v[86:87], v[84:85], v[76:77] op_sel:[0,0] op_sel_hi:[0,1]
    v_pk_fma_f32 v[86:87], v[84:85], v[76:77], v[86:87] op_sel:[1,1,0] op_sel_hi:[1,0,1] neg_lo:[0,1,0]
    v_cvt_pk_bf16_f32 v91, v86, -v87
    ds_write_b32 v16, v91 offset:1088
    v_pk_mul_f32 v[80:81], v[86:87], v[74:75] op_sel:[0,0] op_sel_hi:[0,1]
    v_pk_fma_f32 v[80:81], v[86:87], v[74:75], v[80:81] op_sel:[1,1,0] op_sel_hi:[1,0,1] neg_lo:[0,1,0]
    v_cvt_pk_bf16_f32 v88, v80, -v81
    ds_write_b32 v16, v88 offset:1360
    v_pk_mul_f32 v[84:85], v[86:87], v[76:77] op_sel:[0,0] op_sel_hi:[0,1]
    v_pk_fma_f32 v[84:85], v[86:87], v[76:77], v[84:85] op_sel:[1,1,0] op_sel_hi:[1,0,1] neg_lo:[0,1,0]
    v_cvt_pk_bf16_f32 v89, v84, -v85
    ds_write_b32 v16, v89 offset:1632
    v_pk_mul_f32 v[82:83], v[84:85], v[74:75] op_sel:[0,0] op_sel_hi:[0,1]
    v_pk_fma_f32 v[82:83], v[84:85], v[74:75], v[82:83] op_sel:[1,1,0] op_sel_hi:[1,0,1] neg_lo:[0,1,0]
    v_cvt_pk_bf16_f32 v90, v82, -v83
    ds_write_b32 v16, v90 offset:1904
    ds_read_b128 v[132:135], v17 offset:0
    ds_read_b128 v[136:139], v17 offset:32
    ds_read_b128 v[140:143], v17 offset:64
    ds_read_b128 v[144:147], v17 offset:96
    ds_read_b128 v[148:151], v17 offset:128
    ds_read_b128 v[152:155], v17 offset:160
    ds_read_b128 v[156:159], v17 offset:192
    ds_read_b128 v[160:163], v17 offset:224
    s_add_u32 m0, s93, 7392
    s_add_u32 s94, s92, 7168
    buffer_load_dwordx4 v7, s[32:35], s94 offen lds
    s_add_u32 m0, s93, 8448
    s_add_u32 s94, s92, 8192
    buffer_load_dwordx4 v7, s[32:35], s94 offen lds
    s_waitcnt lgkmcnt(7)
    v_mfma_f32_32x32x16_bf16 v[240:255], v[132:135], v[100:103], 0
    s_add_u32 m0, s93, 9504
    s_add_u32 s94, s92, 9216
    buffer_load_dwordx4 v7, s[32:35], s94 offen lds
    s_waitcnt lgkmcnt(6)
    v_mfma_f32_32x32x16_bf16 v[240:255], v[136:139], v[104:107], v[240:255]
    s_add_u32 m0, s93, 10560
    s_add_u32 s94, s92, 10240
    buffer_load_dwordx4 v7, s[32:35], s94 offen lds
    s_waitcnt lgkmcnt(5)
    v_mfma_f32_32x32x16_bf16 v[240:255], v[140:143], v[108:111], v[240:255]
    s_add_u32 m0, s93, 11616
    s_add_u32 s94, s92, 11264
    buffer_load_dwordx4 v7, s[32:35], s94 offen lds
    s_waitcnt lgkmcnt(4)
    v_mfma_f32_32x32x16_bf16 v[240:255], v[144:147], v[112:115], v[240:255]
    s_add_u32 m0, s93, 12672
    s_add_u32 s94, s92, 12288
    buffer_load_dwordx4 v7, s[32:35], s94 offen lds
    s_waitcnt lgkmcnt(3)
    v_mfma_f32_32x32x16_bf16 v[240:255], v[148:151], v[116:119], v[240:255]
    s_add_u32 m0, s93, 13728
    s_add_u32 s94, s92, 13312
    buffer_load_dwordx4 v7, s[32:35], s94 offen lds
    s_waitcnt lgkmcnt(2)
    v_mfma_f32_32x32x16_bf16 v[240:255], v[152:155], v[120:123], v[240:255]
    s_add_u32 m0, s93, 14784
    s_add_u32 s94, s92, 14336
    buffer_load_dwordx4 v7, s[32:35], s94 offen lds
    s_waitcnt lgkmcnt(1)
    v_mfma_f32_32x32x16_bf16 v[240:255], v[156:159], v[124:127], v[240:255]
    s_add_u32 m0, s93, 15840
    s_add_u32 s94, s92, 15360
    buffer_load_dwordx4 v7, s[32:35], s94 offen lds
    s_waitcnt lgkmcnt(0)
    v_mfma_f32_32x32x16_bf16 v[240:255], v[160:163], v[128:131], v[240:255]
    s_add_u32 m0, s73, 0
    s_mov_b32 s94, 0
    buffer_load_dwordx4 v20, s[36:39], s94 offen offset:0 lds
    buffer_load_dwordx4 v21, s[36:39], s94 offen offset:1024 lds
    buffer_load_dwordx4 v22, s[36:39], s94 offen offset:2048 lds
    v_mov_b32 v124, 0x3f803f80
    v_mov_b32 v125, 0x3f803f80
    v_mov_b32 v126, 0x3f803f80
    v_mov_b32 v127, 0x3f803f80
    s_bitcmp1_b32 s95, 0
    s_cbranch_scc1 L_kx1
    s_nop 0
    ds_write_b128 v18, v[244:247] offset:0
    ds_write_b128 v18, v[248:251] offset:1024
    ds_write_b128 v18, v[252:255] offset:2048
    s_branch L_kx2
L_kx1:
    s_nop 7
    ds_write_b128 v18, v[240:243] offset:3072
L_kx2:
    s_lshl_b32 s64, s57, 7
    v_add_u32 v26, s64, v26
    s_mul_i32 s66, s72, 44032
    s_and_b32 s64, s72, 3
    s_lshl_b32 s64, s64, 7
    s_sub_u32 s66, s66, s64
    s_sub_u32 s92, s78, 2097152
    s_add_u32 s93, s78, 32768
    s_mul_i32 s77, s61, 45056
    s_waitcnt vmcnt(3)
    s_waitcnt lgkmcnt(0)
    ds_read_b128 v[128:131], v25 offset:0
    ds_read_b128 v[132:135], v25 offset:64
    ds_read_b128 v[136:139], v25 offset:128
    ds_read_b128 v[140:143], v25 offset:192
    ds_read_b128 v[144:147], v25 offset:256
    ds_read_b128 v[148:151], v25 offset:320
    ds_read_b128 v[152:155], v25 offset:384
    ds_read_b128 v[156:159], v25 offset:448
    ds_read_b128 v[160:163], v25 offset:512
    ds_read_b128 v[164:167], v25 offset:576
    ds_read_b128 v[168:171], v25 offset:640
    ds_read_b128 v[172:175], v25 offset:704
    s_waitcnt lgkmcnt(11)
    v_mfma_f32_16x16x32_bf16 v[192:195], v[124:127], v[128:131], 0
    ds_read_b128 v[176:179], v25 offset:768
    v_mfma_f32_16x16x32_bf16 v[196:199], v[128:131], v[128:131], 0
    s_waitcnt lgkmcnt(11)
    v_mfma_f32_16x16x32_bf16 v[192:195], v[124:127], v[132:135], v[192:195]
    ds_read_b128 v[180:183], v25 offset:832
    v_mfma_f32_16x16x32_bf16 v[196:199], v[132:135], v[132:135], v[196:199]
    s_add_u32 m0, s73, 3072
    s_mov_b32 s94, 88064
    buffer_load_dwordx4 v20, s[36:39], s94 offen offset:0 lds
    s_waitcnt lgkmcnt(11)
    v_mfma_f32_16x16x32_bf16 v[192:195], v[124:127], v[136:139], v[192:195]
    ds_read_b128 v[184:187], v25 offset:896
    v_mfma_f32_16x16x32_bf16 v[196:199], v[136:139], v[136:139], v[196:199]
    buffer_load_dwordx4 v21, s[36:39], s94 offen offset:1024 lds
    s_waitcnt lgkmcnt(11)
    v_mfma_f32_16x16x32_bf16 v[192:195], v[124:127], v[140:143], v[192:195]
    ds_read_b128 v[188:191], v25 offset:960
    v_mfma_f32_16x16x32_bf16 v[196:199], v[140:143], v[140:143], v[196:199]
    buffer_load_dwordx4 v22, s[36:39], s94 offen offset:2048 lds
    s_waitcnt lgkmcnt(11)
    v_mfma_f32_16x16x32_bf16 v[192:195], v[124:127], v[144:147], v[192:195]
    v_mfma_f32_16x16x32_bf16 v[196:199], v[144:147], v[144:147], v[196:199]
    s_waitcnt lgkmcnt(10)
    v_mfma_f32_16x16x32_bf16 v[192:195], v[124:127], v[148:151], v[192:195]
    v_mfma_f32_16x16x32_bf16 v[196:199], v[148:151], v[148:151], v[196:199]
    s_add_u32 m0, s73, 6144
    s_mov_b32 s94, 176128
    buffer_load_dwordx4 v20, s[36:39], s94 offen offset:0 lds
    s_waitcnt lgkmcnt(9)
    v_mfma_f32_16x16x32_bf16 v[192:195], v[124:127], v[152:155], v[192:195]
    v_mfma_f32_16x16x32_bf16 v[196:199], v[152:155], v[152:155], v[196:199]
    buffer_load_dwordx4 v21, s[36:39], s94 offen offset:1024 lds
    s_waitcnt lgkmcnt(8)
    v_mfma_f32_16x16x32_bf16 v[192:195], v[124:127], v[156:159], v[192:195]
    v_mfma_f32_16x16x32_bf16 v[196:199], v[156:159], v[156:159], v[196:199]
    buffer_load_dwordx4 v22, s[36:39], s94 offen offset:2048 lds
    s_waitcnt lgkmcnt(7)
    v_mfma_f32_16x16x32_bf16 v[192:195], v[124:127], v[160:163], v[192:195]
    v_mfma_f32_16x16x32_bf16 v[196:199], v[160:163], v[160:163], v[196:199]
    s_waitcnt lgkmcnt(6)
    v_mfma_f32_16x16x32_bf16 v[192:195], v[124:127], v[164:167], v[192:195]
    v_mfma_f32_16x16x32_bf16 v[196:199], v[164:167], v[164:167], v[196:199]
    s_add_u32 m0, s73, 9216
    s_mov_b32 s94, 264192
    buffer_load_dwordx4 v20, s[36:39], s94 offen offset:0 lds
    s_waitcnt lgkmcnt(5)
    v_mfma_f32_16x16x32_bf16 v[192:195], v[124:127], v[168:171], v[192:195]
    v_mfma_f32_16x16x32_bf16 v[196:199], v[168:171], v[168:171], v[196:199]
    buffer_load_dwordx4 v21, s[36:39], s94 offen offset:1024 lds
    s_waitcnt lgkmcnt(4)
    v_mfma_f32_16x16x32_bf16 v[192:195], v[124:127], v[172:175], v[192:195]
    v_mfma_f32_16x16x32_bf16 v[196:199], v[172:175], v[172:175], v[196:199]
    buffer_load_dwordx4 v22, s[36:39], s94 offen offset:2048 lds
    s_waitcnt lgkmcnt(3)
    v_mfma_f32_16x16x32_bf16 v[192:195], v[124:127], v[176:179], v[192:195]
    v_mfma_f32_16x16x32_bf16 v[196:199], v[176:179], v[176:179], v[196:199]
    s_waitcnt lgkmcnt(2)
    v_mfma_f32_16x16x32_bf16 v[192:195], v[124:127], v[180:183], v[192:195]
    v_mfma_f32_16x16x32_bf16 v[196:199], v[180:183], v[180:183], v[196:199]
    s_add_u32 m0, s73, 12288
    s_mov_b32 s94, 352256
    buffer_load_dwordx4 v20, s[36:39], s94 offen offset:0 lds
    s_waitcnt lgkmcnt(1)
    v_mfma_f32_16x16x32_bf16 v[192:195], v[124:127], v[184:187], v[192:195]
    v_mfma_f32_16x16x32_bf16 v[196:199], v[184:187], v[184:187], v[196:199]
    buffer_load_dwordx4 v21, s[36:39], s94 offen offset:1024 lds
    s_waitcnt lgkmcnt(0)
    v_mfma_f32_16x16x32_bf16 v[192:195], v[124:127], v[188:191], v[192:195]
    v_mfma_f32_16x16x32_bf16 v[196:199], v[188:191], v[188:191], v[196:199]
    buffer_load_dwordx4 v22, s[36:39], s94 offen offset:2048 lds
    s_barrier
    s_waitcnt vmcnt(12)
    ds_read_b64_tr_b16 v[128:129], v23 offset:0
    ds_read_b64_tr_b16 v[130:131], v23 offset:768
    ds_read_b64_tr_b16 v[132:133], v23 offset:32
    ds_read_b64_tr_b16 v[134:135], v23 offset:800
    ds_read_b64_tr_b16 v[136:137], v23 offset:64
    ds_read_b64_tr_b16 v[138:139], v23 offset:832
    ds_read_b128 v[152:155], v24 offset:0
    ds_read_b128 v[156:159], v24 offset:16896
    ds_read_b128 v[160:163], v24 offset:33792
    ds_read_b128 v[164:167], v24 offset:50688
    v_cndmask_b32 v216, v196, v197, s[86:87]
    v_mul_f32 v217, 0x3b000000, v192
    v_cndmask_b32 v216, v216, v198, s[88:89]
    v_cndmask_b32 v216, v216, v199, s[90:91]
    v_mul_f32 v216, 0x3b000000, v216
    v_fma_f32 v216, -v217, v217, v216
    v_cvt_pk_bf16_f32 v217, v217, v217
    v_max_f32 v216, 0, v216
    s_waitcnt lgkmcnt(0)
    v_mfma_f32_16x16x32_bf16 v[64:67], v[128:131], v[152:155], 0
    v_cvt_pk_bf16_f32 v216, v216, v216
    v_and_b32 v217, 0xffff0000, v217
    v_and_b32 v216, 0xffff0000, v216
    v_mfma_f32_16x16x32_bf16 v[68:71], v[128:131], v[156:159], 0
    v_add_f32 v216, 0x3727c5ac, v216
    v_cvt_pk_bf16_f32 v216, v216, v216
    v_mfma_f32_16x16x32_bf16 v[72:75], v[128:131], v[160:163], 0
    v_and_b32 v216, 0xffff0000, v216
    v_sqrt_f32 v216, v216
    v_mfma_f32_16x16x32_bf16 v[76:79], v[128:131], v[164:167], 0
    v_cvt_pk_bf16_f32 v216, v216, v216
    v_and_b32 v216, 0xffff0000, v216
    v_mfma_f32_16x16x32_bf16 v[112:115], v[128:131], v[124:127], 0
    v_rcp_f32 v216, v216
    s_mov_b64 exec, s[84:85]
    ds_write_b32 v29, v217
    ds_write_b32 v29, v216 offset:256
    s_mov_b64 exec, -1
    v_mfma_f32_16x16x32_bf16 v[80:83], v[132:135], v[152:155], 0
    ds_read_b64_tr_b16 v[200:201], v26 offset:0
    ds_read_b64_tr_b16 v[202:203], v26 offset:4224
    v_mfma_f32_16x16x32_bf16 v[84:87], v[132:135], v[156:159], 0
    ds_read_b64_tr_b16 v[204:205], v26 offset:33792
    ds_read_b64_tr_b16 v[206:207], v26 offset:38016
    v_mfma_f32_16x16x32_bf16 v[88:91], v[132:135], v[160:163], 0
    s_add_u32 m0, s73, 15360
    s_mov_b32 s94, 440320
    buffer_load_dwordx4 v20, s[36:39], s94 offen offset:0 lds
    ds_read_b128 v[168:171], v24 offset:64
    v_mfma_f32_16x16x32_bf16 v[92:95], v[132:135], v[164:167], 0
    ds_read_b128 v[172:175], v24 offset:16960
    buffer_load_dwordx4 v21, s[36:39], s94 offen offset:1024 lds
    v_mfma_f32_16x16x32_bf16 v[116:119], v[132:135], v[124:127], 0
    ds_read_b128 v[176:179], v24 offset:33856
    ds_read_b128 v[180:183], v24 offset:50752
    v_mfma_f32_16x16x32_bf16 v[96:99], v[136:139], v[152:155], 0
    buffer_load_dwordx4 v22, s[36:39], s94 offen offset:2048 lds
    s_waitcnt vmcnt(12)
    ds_read_b64_tr_b16 v[140:141], v23 offset:3072
    v_mfma_f32_16x16x32_bf16 v[100:103], v[136:139], v[156:159], 0
    s_add_u32 m0, s73, 0
    s_mov_b32 s94, 528384
    buffer_load_dwordx4 v20, s[36:39], s94 offen offset:0 lds
    ds_read_b64_tr_b16 v[142:143], v23 offset:3840
    v_mfma_f32_16x16x32_bf16 v[104:107], v[136:139], v[160:163], 0
    ds_read_b64_tr_b16 v[144:145], v23 offset:3104
    buffer_load_dwordx4 v21, s[36:39], s94 offen offset:1024 lds
    v_mfma_f32_16x16x32_bf16 v[108:111], v[136:139], v[164:167], 0
    ds_read_b64_tr_b16 v[146:147], v23 offset:3872
    ds_read_b64_tr_b16 v[148:149], v23 offset:3136
    v_mfma_f32_16x16x32_bf16 v[120:123], v[136:139], v[124:127], 0
    buffer_load_dwordx4 v22, s[36:39], s94 offen offset:2048 lds
    ds_read_b64_tr_b16 v[150:151], v23 offset:3904
    s_waitcnt lgkmcnt(0)
    s_barrier
    v_mfma_f32_16x16x32_bf16 v[64:67], v[140:143], v[168:171], v[64:67]
    ds_read_b128 v[208:211], v27 offset:0
    s_add_u32 m0, s73, 3072
    s_mov_b32 s94, 616448
    buffer_load_dwordx4 v20, s[36:39], s94 offen offset:0 lds
    v_mfma_f32_16x16x32_bf16 v[68:71], v[140:143], v[172:175], v[68:71]
    ds_read_b128 v[152:155], v24 offset:128
    v_mfma_f32_16x16x32_bf16 v[72:75], v[140:143], v[176:179], v[72:75]
    ds_read_b128 v[156:159], v24 offset:17024
    v_mfma_f32_16x16x32_bf16 v[76:79], v[140:143], v[180:183], v[76:79]
    buffer_load_dwordx4 v21, s[36:39], s94 offen offset:1024 lds
    ds_read_b128 v[212:215], v27 offset:16
    v_mfma_f32_16x16x32_bf16 v[112:115], v[140:143], v[124:127], v[112:115]
    ds_read_b128 v[160:163], v24 offset:33920
    v_mfma_f32_16x16x32_bf16 v[80:83], v[144:147], v[168:171], v[80:83]
    ds_read_b128 v[164:167], v24 offset:50816
    v_mfma_f32_16x16x32_bf16 v[84:87], v[144:147], v[172:175], v[84:87]
    buffer_load_dwordx4 v22, s[36:39], s94 offen offset:2048 lds
    v_mfma_f32_16x16x32_bf16 v[88:91], v[144:147], v[176:179], v[88:91]
    s_waitcnt vmcnt(15)
    ds_read_b64_tr_b16 v[128:129], v23 offset:6144
    ds_read_b128 v[224:227], v27 offset:256
    v_mfma_f32_16x16x32_bf16 v[92:95], v[144:147], v[180:183], v[92:95]
    ds_read_b64_tr_b16 v[130:131], v23 offset:6912
    v_mfma_f32_16x16x32_bf16 v[116:119], v[144:147], v[124:127], v[116:119]
    v_add_co_u32 v58, vcc, 16384, v56
    s_nop 1
    v_addc_co_u32 v59, vcc, 0, v57, vcc
    global_load_dwordx4 v[32:35], v[58:59], off offset:-4096
    v_mfma_f32_16x16x32_bf16 v[96:99], v[148:151], v[168:171], v[96:99]
    ds_read_b64_tr_b16 v[132:133], v23 offset:6176
    v_mfma_f32_16x16x32_bf16 v[100:103], v[148:151], v[172:175], v[100:103]
    ds_read_b64_tr_b16 v[134:135], v23 offset:6944
    ds_read_b128 v[228:231], v27 offset:272
    v_mfma_f32_16x16x32_bf16 v[104:107], v[148:151], v[176:179], v[104:107]
    global_load_dwordx4 v[36:39], v[58:59], off
    v_mfma_f32_16x16x32_bf16 v[108:111], v[148:151], v[180:183], v[108:111]
    ds_read_b64_tr_b16 v[136:137], v23 offset:6208
    v_mfma_f32_16x16x32_bf16 v[120:123], v[148:151], v[124:127], v[120:123]
    ds_read_b64_tr_b16 v[138:139], v23 offset:6976
    s_waitcnt lgkmcnt(0)
    v_mfma_f32_16x16x32_bf16 v[64:67], v[128:131], v[152:155], v[64:67]
    v_lshlrev_b32 v218, 16, v200
    s_add_u32 m0, s73, 6144
    s_mov_b32 s94, 704512
    buffer_load_dwordx4 v20, s[36:39], s94 offen offset:0 lds
    v_and_b32 v219, 0xffff0000, v200
    v_mfma_f32_16x16x32_bf16 v[68:71], v[128:131], v[156:159], v[68:71]
    ds_read_b128 v[168:171], v24 offset:192
    v_sub_f32 v218, v218, v208
    v_mfma_f32_16x16x32_bf16 v[72:75], v[128:131], v[160:163], v[72:75]
    ds_read_b128 v[172:175], v24 offset:17088
    v_sub_f32 v219, v219, v209
    v_mfma_f32_16x16x32_bf16 v[76:79], v[128:131], v[164:167], v[76:79]
    v_cvt_pk_bf16_f32 v200, v218, v219
    buffer_load_dwordx4 v21, s[36:39], s94 offen offset:1024 lds
    v_lshlrev_b32 v218, 16, v200
    v_mfma_f32_16x16x32_bf16 v[112:115], v[128:131], v[124:127], v[112:115]
    ds_read_b128 v[176:179], v24 offset:33984
    v_and_b32 v219, 0xffff0000, v200
    v_mfma_f32_16x16x32_bf16 v[80:83], v[132:135], v[152:155], v[80:83]
    ds_read_b128 v[180:183], v24 offset:50880
    v_mul_f32 v218, v218, v224
    v_mfma_f32_16x16x32_bf16 v[84:87], v[132:135], v[156:159], v[84:87]
    v_mul_f32 v219, v219, v225
    buffer_load_dwordx4 v22, s[36:39], s94 offen offset:2048 lds
    v_cvt_pk_bf16_f32 v184, v218, v219
    v_mfma_f32_16x16x32_bf16 v[88:91], v[132:135], v[160:163], v[88:91]
    s_waitcnt vmcnt(17)
    ds_read_b64_tr_b16 v[140:141], v23 offset:9216
    v_lshlrev_b32 v220, 16, v201
    v_mfma_f32_16x16x32_bf16 v[92:95], v[132:135], v[164:167], v[92:95]
    ds_read_b64_tr_b16 v[142:143], v23 offset:9984
    v_and_b32 v221, 0xffff0000, v201
    v_mfma_f32_16x16x32_bf16 v[116:119], v[132:135], v[124:127], v[116:119]
    v_sub_f32 v220, v220, v210
    v_add_co_u32 v58, vcc, 24576, v56
    s_nop 1
    v_addc_co_u32 v59, vcc, 0, v57, vcc
    global_load_dwordx4 v[40:43], v[58:59], off offset:-4096
    v_sub_f32 v221, v221, v211
    v_mfma_f32_16x16x32_bf16 v[96:99], v[136:139], v[152:155], v[96:99]
    ds_read_b64_tr_b16 v[144:145], v23 offset:9248
    v_cvt_pk_bf16_f32 v201, v220, v221
    v_mfma_f32_16x16x32_bf16 v[100:103], v[136:139], v[156:159], v[100:103]
    ds_read_b64_tr_b16 v[146:147], v23 offset:10016
    v_lshlrev_b32 v220, 16, v201
    v_mfma_f32_16x16x32_bf16 v[104:107], v[136:139], v[160:163], v[104:107]
    v_and_b32 v221, 0xffff0000, v201
    global_load_dwordx4 v[44:47], v[58:59], off
    v_mul_f32 v220, v220, v226
    v_mfma_f32_16x16x32_bf16 v[108:111], v[136:139], v[164:167], v[108:111]
    ds_read_b64_tr_b16 v[148:149], v23 offset:9280
    v_mul_f32 v221, v221, v227
    v_mfma_f32_16x16x32_bf16 v[120:123], v[136:139], v[124:127], v[120:123]
    ds_read_b64_tr_b16 v[150:151], v23 offset:10048
    v_cvt_pk_bf16_f32 v185, v220, v221
    s_waitcnt lgkmcnt(0)
    v_mfma_f32_16x16x32_bf16 v[64:67], v[140:143], v[168:171], v[64:67]
    v_lshlrev_b32 v218, 16, v202
    s_add_u32 m0, s73, 9216
    s_mov_b32 s94, 792576
    buffer_load_dwordx4 v20, s[36:39], s94 offen offset:0 lds
    v_and_b32 v219, 0xffff0000, v202
    v_mfma_f32_16x16x32_bf16 v[68:71], v[140:143], v[172:175], v[68:71]
    ds_read_b128 v[152:155], v24 offset:256
    v_sub_f32 v218, v218, v212
    v_sub_f32 v219, v219, v213
    v_mfma_f32_16x16x32_bf16 v[72:75], v[140:143], v[176:179], v[72:75]
    ds_read_b128 v[156:159], v24 offset:17152
    v_cvt_pk_bf16_f32 v202, v218, v219
    v_mfma_f32_16x16x32_bf16 v[76:79], v[140:143], v[180:183], v[76:79]
    v_lshlrev_b32 v218, 16, v202
    buffer_load_dwordx4 v21, s[36:39], s94 offen offset:1024 lds
    v_and_b32 v219, 0xffff0000, v202
    v_mfma_f32_16x16x32_bf16 v[112:115], v[140:143], v[124:127], v[112:115]
    ds_read_b128 v[160:163], v24 offset:34048
    v_mul_f32 v218, v218, v228
    v_mul_f32 v219, v219, v229
    v_mfma_f32_16x16x32_bf16 v[80:83], v[144:147], v[168:171], v[80:83]
    ds_read_b128 v[164:167], v24 offset:50944
    v_cvt_pk_bf16_f32 v186, v218, v219
    v_mfma_f32_16x16x32_bf16 v[84:87], v[144:147], v[172:175], v[84:87]
    v_lshlrev_b32 v220, 16, v203
    buffer_load_dwordx4 v22, s[36:39], s94 offen offset:2048 lds
    v_and_b32 v221, 0xffff0000, v203
    v_mfma_f32_16x16x32_bf16 v[88:91], v[144:147], v[176:179], v[88:91]
    s_waitcnt vmcnt(19)
    ds_read_b64_tr_b16 v[128:129], v23 offset:12288
    v_sub_f32 v220, v220, v214
    v_sub_f32 v221, v221, v215
    v_mfma_f32_16x16x32_bf16 v[92:95], v[144:147], v[180:183], v[92:95]
    ds_read_b64_tr_b16 v[130:131], v23 offset:13056
    v_cvt_pk_bf16_f32 v203, v220, v221
    v_mfma_f32_16x16x32_bf16 v[116:119], v[144:147], v[124:127], v[116:119]
    v_lshlrev_b32 v220, 16, v203
    v_add_co_u32 v58, vcc, 32768, v56
    s_nop 1
    v_addc_co_u32 v59, vcc, 0, v57, vcc
    global_load_dwordx4 v[48:51], v[58:59], off offset:-4096
    v_and_b32 v221, 0xffff0000, v203
    v_mfma_f32_16x16x32_bf16 v[96:99], v[148:151], v[168:171], v[96:99]
    ds_read_b64_tr_b16 v[132:133], v23 offset:12320
    v_mul_f32 v220, v220, v230
    v_mul_f32 v221, v221, v231
    v_mfma_f32_16x16x32_bf16 v[100:103], v[148:151], v[172:175], v[100:103]
    ds_read_b64_tr_b16 v[134:135], v23 offset:13088
    v_cvt_pk_bf16_f32 v187, v220, v221
    v_mfma_f32_16x16x32_bf16 v[104:107], v[148:151], v[176:179], v[104:107]
    buffer_store_dwordx4 v[184:187], v30, s[48:51], s92 offen offset:0 sc1
    global_load_dwordx4 v[52:55], v[58:59], off
    ds_read_b128 v[208:211], v27 offset:128
    v_mfma_f32_16x16x32_bf16 v[108:111], v[148:151], v[180:183], v[108:111]
    ds_read_b64_tr_b16 v[136:137], v23 offset:12352
    ds_read_b128 v[212:215], v27 offset:144
    ds_read_b128 v[224:227], v27 offset:384
    v_mfma_f32_16x16x32_bf16 v[120:123], v[148:151], v[124:127], v[120:123]
    ds_read_b64_tr_b16 v[138:139], v23 offset:13120
    ds_read_b128 v[228:231], v27 offset:400
    s_waitcnt lgkmcnt(1)
    s_waitcnt lgkmcnt(0)
    v_mfma_f32_16x16x32_bf16 v[64:67], v[128:131], v[152:155], v[64:67]
    v_lshlrev_b32 v218, 16, v204
    ds_read_b128 v[168:171], v24 offset:320
    v_and_b32 v219, 0xffff0000, v204
    v_mfma_f32_16x16x32_bf16 v[68:71], v[128:131], v[156:159], v[68:71]
    s_add_u32 m0, s73, 12288
    s_mov_b32 s94, 880640
    buffer_load_dwordx4 v20, s[36:39], s94 offen offset:0 lds
    v_sub_f32 v218, v218, v208
    v_mfma_f32_16x16x32_bf16 v[72:75], v[128:131], v[160:163], v[72:75]
    v_sub_f32 v219, v219, v209
    ds_read_b128 v[172:175], v24 offset:17216
    v_mfma_f32_16x16x32_bf16 v[76:79], v[128:131], v[164:167], v[76:79]
    v_cvt_pk_bf16_f32 v204, v218, v219
    ds_read_b128 v[176:179], v24 offset:34112
    v_mfma_f32_16x16x32_bf16 v[112:115], v[128:131], v[124:127], v[112:115]
    v_lshlrev_b32 v218, 16, v204
    v_and_b32 v219, 0xffff0000, v204
    v_mfma_f32_16x16x32_bf16 v[80:83], v[132:135], v[152:155], v[80:83]
    ds_read_b128 v[180:183], v24 offset:51008
    v_mul_f32 v218, v218, v224
    buffer_load_dwordx4 v21, s[36:39], s94 offen offset:1024 lds
    v_mfma_f32_16x16x32_bf16 v[84:87], v[132:135], v[156:159], v[84:87]
    v_mul_f32 v219, v219, v225
    v_cvt_pk_bf16_f32 v188, v218, v219
    v_mfma_f32_16x16x32_bf16 v[88:91], v[132:135], v[160:163], v[88:91]
    s_waitcnt vmcnt(21)
    ds_read_b64_tr_b16 v[140:141], v23 offset:15360
    v_lshlrev_b32 v220, 16, v205
    v_mfma_f32_16x16x32_bf16 v[92:95], v[132:135], v[164:167], v[92:95]
    ds_read_b64_tr_b16 v[142:143], v23 offset:16128
    v_and_b32 v221, 0xffff0000, v205
    v_mfma_f32_16x16x32_bf16 v[116:119], v[132:135], v[124:127], v[116:119]
    v_sub_f32 v220, v220, v210
    ds_read_b64_tr_b16 v[144:145], v23 offset:15392
    v_mfma_f32_16x16x32_bf16 v[96:99], v[136:139], v[152:155], v[96:99]
    v_sub_f32 v221, v221, v211
    buffer_load_dwordx4 v22, s[36:39], s94 offen offset:2048 lds
    v_cvt_pk_bf16_f32 v205, v220, v221
    v_mfma_f32_16x16x32_bf16 v[100:103], v[136:139], v[156:159], v[100:103]
    v_lshlrev_b32 v220, 16, v205
    ds_read_b64_tr_b16 v[146:147], v23 offset:16160
    v_mfma_f32_16x16x32_bf16 v[104:107], v[136:139], v[160:163], v[104:107]
    v_and_b32 v221, 0xffff0000, v205
    ds_read_b64_tr_b16 v[148:149], v23 offset:15424
    v_mfma_f32_16x16x32_bf16 v[108:111], v[136:139], v[164:167], v[108:111]
    v_mul_f32 v220, v220, v226
    v_mul_f32 v221, v221, v227
    v_mfma_f32_16x16x32_bf16 v[120:123], v[136:139], v[124:127], v[120:123]
    ds_read_b64_tr_b16 v[150:151], v23 offset:16192
    v_cvt_pk_bf16_f32 v189, v220, v221
    s_waitcnt lgkmcnt(0)
    v_mfma_f32_16x16x32_bf16 v[64:67], v[140:143], v[168:171], v[64:67]
    v_lshlrev_b32 v218, 16, v206
    ds_read_b128 v[152:155], v24 offset:384
    v_and_b32 v219, 0xffff0000, v206
    v_mfma_f32_16x16x32_bf16 v[68:71], v[140:143], v[172:175], v[68:71]
    s_add_u32 m0, s73, 15360
    s_mov_b32 s94, 968704
    buffer_load_dwordx4 v20, s[36:39], s94 offen offset:0 lds
    v_sub_f32 v218, v218, v212
    v_mfma_f32_16x16x32_bf16 v[72:75], v[140:143], v[176:179], v[72:75]
    v_sub_f32 v219, v219, v213
    ds_read_b128 v[156:159], v24 offset:17280
    v_mfma_f32_16x16x32_bf16 v[76:79], v[140:143], v[180:183], v[76:79]
    v_cvt_pk_bf16_f32 v206, v218, v219
    ds_read_b128 v[160:163], v24 offset:34176
    v_lshlrev_b32 v218, 16, v206
    v_mfma_f32_16x16x32_bf16 v[112:115], v[140:143], v[124:127], v[112:115]
    v_and_b32 v219, 0xffff0000, v206
    ds_read_b128 v[164:167], v24 offset:51072
    v_mfma_f32_16x16x32_bf16 v[80:83], v[144:147], v[168:171], v[80:83]
    v_mul_f32 v218, v218, v228
    v_mul_f32 v219, v219, v229
    v_mfma_f32_16x16x32_bf16 v[84:87], v[144:147], v[172:175], v[84:87]
    buffer_load_dwordx4 v21, s[36:39], s94 offen offset:1024 lds
    v_cvt_pk_bf16_f32 v190, v218, v219
    v_mfma_f32_16x16x32_bf16 v[88:91], v[144:147], v[176:179], v[88:91]
    s_waitcnt vmcnt(21)
    ds_read_b64_tr_b16 v[128:129], v23 offset:0
    v_lshlrev_b32 v220, 16, v207
    v_and_b32 v221, 0xffff0000, v207
    v_mfma_f32_16x16x32_bf16 v[92:95], v[144:147], v[180:183], v[92:95]
    ds_read_b64_tr_b16 v[130:131], v23 offset:768
    v_sub_f32 v220, v220, v214
    v_mfma_f32_16x16x32_bf16 v[116:119], v[144:147], v[124:127], v[116:119]
    ds_read_b64_tr_b16 v[132:133], v23 offset:32
    v_sub_f32 v221, v221, v215
    v_mfma_f32_16x16x32_bf16 v[96:99], v[148:151], v[168:171], v[96:99]
    v_cvt_pk_bf16_f32 v207, v220, v221
    buffer_load_dwordx4 v22, s[36:39], s94 offen offset:2048 lds
    v_mfma_f32_16x16x32_bf16 v[100:103], v[148:151], v[172:175], v[100:103]
    v_lshlrev_b32 v220, 16, v207
    v_and_b32 v221, 0xffff0000, v207
    ds_read_b64_tr_b16 v[134:135], v23 offset:800
    v_mfma_f32_16x16x32_bf16 v[104:107], v[148:151], v[176:179], v[104:107]
    v_mul_f32 v220, v220, v230
    ds_read_b64_tr_b16 v[136:137], v23 offset:64
    v_mfma_f32_16x16x32_bf16 v[108:111], v[148:151], v[180:183], v[108:111]
    v_mul_f32 v221, v221, v231
    v_cvt_pk_bf16_f32 v191, v220, v221
    v_mfma_f32_16x16x32_bf16 v[120:123], v[148:151], v[124:127], v[120:123]
    ds_read_b64_tr_b16 v[138:139], v23 offset:832
    buffer_store_dwordx4 v[188:191], v30, s[48:51], s92 offen offset:64 sc1
    s_waitcnt lgkmcnt(0)
    v_mfma_f32_16x16x32_bf16 v[64:67], v[128:131], v[152:155], v[64:67]
    ds_read_b128 v[200:203], v18 offset:3072
    ds_read_b128 v[168:171], v24 offset:448
    v_mfma_f32_16x16x32_bf16 v[68:71], v[128:131], v[156:159], v[68:71]
    s_add_u32 m0, s73, 0
    s_mov_b32 s94, 1056768
    buffer_load_dwordx4 v20, s[36:39], s94 offen offset:0 lds
    v_mfma_f32_16x16x32_bf16 v[72:75], v[128:131], v[160:163], v[72:75]
    ds_read_b128 v[172:175], v24 offset:17344
    v_mfma_f32_16x16x32_bf16 v[76:79], v[128:131], v[164:167], v[76:79]
    ds_read_b128 v[176:179], v24 offset:34240
    v_mfma_f32_16x16x32_bf16 v[112:115], v[128:131], v[124:127], v[112:115]
    ds_read_b128 v[204:207], v18 offset:0
    v_mfma_f32_16x16x32_bf16 v[80:83], v[132:135], v[152:155], v[80:83]
    ds_read_b128 v[180:183], v24 offset:51136
    v_mfma_f32_16x16x32_bf16 v[84:87], v[132:135], v[156:159], v[84:87]
    buffer_load_dwordx4 v21, s[36:39], s94 offen offset:1024 lds
    v_mfma_f32_16x16x32_bf16 v[88:91], v[132:135], v[160:163], v[88:91]
    s_waitcnt vmcnt(22)
    ds_read_b64_tr_b16 v[140:141], v23 offset:3072
    ds_read_b128 v[208:211], v18 offset:1024
    v_mfma_f32_16x16x32_bf16 v[92:95], v[132:135], v[164:167], v[92:95]
    ds_read_b64_tr_b16 v[142:143], v23 offset:3840
    v_mfma_f32_16x16x32_bf16 v[116:119], v[132:135], v[124:127], v[116:119]
    ds_read_b64_tr_b16 v[144:145], v23 offset:3104
    v_mfma_f32_16x16x32_bf16 v[96:99], v[136:139], v[152:155], v[96:99]
    buffer_load_dwordx4 v22, s[36:39], s94 offen offset:2048 lds
    v_mfma_f32_16x16x32_bf16 v[100:103], v[136:139], v[156:159], v[100:103]
    ds_read_b128 v[212:215], v18 offset:2048
    v_mfma_f32_16x16x32_bf16 v[104:107], v[136:139], v[160:163], v[104:107]
    ds_read_b64_tr_b16 v[146:147], v23 offset:3872
    v_mfma_f32_16x16x32_bf16 v[108:111], v[136:139], v[164:167], v[108:111]
    ds_read_b64_tr_b16 v[148:149], v23 offset:3136
    v_mfma_f32_16x16x32_bf16 v[120:123], v[136:139], v[124:127], v[120:123]
    ds_read_b64_tr_b16 v[150:151], v23 offset:3904
    s_waitcnt lgkmcnt(0)
    v_mfma_f32_16x16x32_bf16 v[64:67], v[140:143], v[168:171], v[64:67]
    ds_read_b128 v[152:155], v24 offset:512
    v_mfma_f32_16x16x32_bf16 v[68:71], v[140:143], v[172:175], v[68:71]
    s_add_u32 m0, s73, 3072
    s_mov_b32 s94, 1144832
    buffer_load_dwordx4 v20, s[36:39], s94 offen offset:0 lds
    v_mfma_f32_16x16x32_bf16 v[72:75], v[140:143], v[176:179], v[72:75]
    v_add_f32 v240, v240, v200
    ds_read_b128 v[156:159], v24 offset:17408
    v_mfma_f32_16x16x32_bf16 v[76:79], v[140:143], v[180:183], v[76:79]
    v_add_f32 v241, v241, v201
    v_mfma_f32_16x16x32_bf16 v[112:115], v[140:143], v[124:127], v[112:115]
    ds_read_b128 v[160:163], v24 offset:34304
    ds_read_b128 v[164:167], v24 offset:51200
    v_mfma_f32_16x16x32_bf16 v[80:83], v[144:147], v[168:171], v[80:83]
    v_add_f32 v242, v242, v202
    v_mfma_f32_16x16x32_bf16 v[84:87], v[144:147], v[172:175], v[84:87]
    buffer_load_dwordx4 v21, s[36:39], s94 offen offset:1024 lds
    v_add_f32 v243, v243, v203
    v_mfma_f32_16x16x32_bf16 v[88:91], v[144:147], v[176:179], v[88:91]
    s_waitcnt vmcnt(20)
    ds_read_b64_tr_b16 v[128:129], v23 offset:6144
    v_mfma_f32_16x16x32_bf16 v[92:95], v[144:147], v[180:183], v[92:95]
    ds_read_b64_tr_b16 v[130:131], v23 offset:6912
    v_add_f32 v244, v244, v204
    v_mfma_f32_16x16x32_bf16 v[116:119], v[144:147], v[124:127], v[116:119]
    ds_read_b64_tr_b16 v[132:133], v23 offset:6176
    v_mfma_f32_16x16x32_bf16 v[96:99], v[148:151], v[168:171], v[96:99]
    v_add_f32 v245, v245, v205
    buffer_load_dwordx4 v22, s[36:39], s94 offen offset:2048 lds
    v_mfma_f32_16x16x32_bf16 v[100:103], v[148:151], v[172:175], v[100:103]
    ds_read_b64_tr_b16 v[134:135], v23 offset:6944
    v_mfma_f32_16x16x32_bf16 v[104:107], v[148:151], v[176:179], v[104:107]
    v_add_f32 v246, v246, v206
    ds_read_b64_tr_b16 v[136:137], v23 offset:6208
    v_mfma_f32_16x16x32_bf16 v[108:111], v[148:151], v[180:183], v[108:111]
    v_add_f32 v247, v247, v207
    v_mfma_f32_16x16x32_bf16 v[120:123], v[148:151], v[124:127], v[120:123]
    ds_read_b64_tr_b16 v[138:139], v23 offset:6976
    s_waitcnt lgkmcnt(0)
    v_mfma_f32_16x16x32_bf16 v[64:67], v[128:131], v[152:155], v[64:67]
    v_add_f32 v248, v248, v208
    ds_read_b128 v[168:171], v24 offset:576
    v_mfma_f32_16x16x32_bf16 v[68:71], v[128:131], v[156:159], v[68:71]
    s_add_u32 m0, s73, 6144
    s_mov_b32 s94, 1232896
    buffer_load_dwordx4 v20, s[36:39], s94 offen offset:0 lds
    v_mfma_f32_16x16x32_bf16 v[72:75], v[128:131], v[160:163], v[72:75]
    v_add_f32 v249, v249, v209
    ds_read_b128 v[172:175], v24 offset:17472
    v_mfma_f32_16x16x32_bf16 v[76:79], v[128:131], v[164:167], v[76:79]
    ds_read_b128 v[176:179], v24 offset:34368
    v_mfma_f32_16x16x32_bf16 v[112:115], v[128:131], v[124:127], v[112:115]
    v_add_f32 v250, v250, v210
    v_mfma_f32_16x16x32_bf16 v[80:83], v[132:135], v[152:155], v[80:83]
    ds_read_b128 v[180:183], v24 offset:51264
    v_add_f32 v251, v251, v211
    v_mfma_f32_16x16x32_bf16 v[84:87], v[132:135], v[156:159], v[84:87]
    buffer_load_dwordx4 v21, s[36:39], s94 offen offset:1024 lds
    v_mfma_f32_16x16x32_bf16 v[88:91], v[132:135], v[160:163], v[88:91]
    s_waitcnt vmcnt(18)
    ds_read_b64_tr_b16 v[140:141], v23 offset:9216
    v_add_f32 v252, v252, v212
    v_mfma_f32_16x16x32_bf16 v[92:95], v[132:135], v[164:167], v[92:95]
    ds_read_b64_tr_b16 v[142:143], v23 offset:9984
    v_mfma_f32_16x16x32_bf16 v[116:119], v[132:135], v[124:127], v[116:119]
    ds_read_b64_tr_b16 v[144:145], v23 offset:9248
    v_mfma_f32_16x16x32_bf16 v[96:99], v[136:139], v[152:155], v[96:99]
    v_add_f32 v253, v253, v213
    buffer_load_dwordx4 v22, s[36:39], s94 offen offset:2048 lds
    v_mfma_f32_16x16x32_bf16 v[100:103], v[136:139], v[156:159], v[100:103]
    v_add_f32 v254, v254, v214
    v_mfma_f32_16x16x32_bf16 v[104:107], v[136:139], v[160:163], v[104:107]
    ds_read_b64_tr_b16 v[146:147], v23 offset:10016
    ds_read_b64_tr_b16 v[148:149], v23 offset:9280
    v_mfma_f32_16x16x32_bf16 v[108:111], v[136:139], v[164:167], v[108:111]
    v_add_f32 v255, v255, v215
    v_mfma_f32_16x16x32_bf16 v[120:123], v[136:139], v[124:127], v[120:123]
    ds_read_b64_tr_b16 v[150:151], v23 offset:10048
    s_waitcnt lgkmcnt(0)
    v_mfma_f32_16x16x32_bf16 v[64:67], v[140:143], v[168:171], v[64:67]
    s_add_u32 m0, s73, 9216
    s_mov_b32 s94, 1320960
    buffer_load_dwordx4 v20, s[36:39], s94 offen offset:0 lds
    v_mfma_f32_16x16x32_bf16 v[68:71], v[140:143], v[172:175], v[68:71]
    ds_read_b128 v[152:155], v24 offset:640
    v_mfma_f32_16x16x32_bf16 v[72:75], v[140:143], v[176:179], v[72:75]
    ds_read_b128 v[156:159], v24 offset:17536
    v_mfma_f32_16x16x32_bf16 v[76:79], v[140:143], v[180:183], v[76:79]
    ds_read_b128 v[160:163], v24 offset:34432
    v_mfma_f32_16x16x32_bf16 v[112:115], v[140:143], v[124:127], v[112:115]
    buffer_load_dwordx4 v21, s[36:39], s94 offen offset:1024 lds
    v_mfma_f32_16x16x32_bf16 v[80:83], v[144:147], v[168:171], v[80:83]
    ds_read_b128 v[164:167], v24 offset:51328
    v_mfma_f32_16x16x32_bf16 v[84:87], v[144:147], v[172:175], v[84:87]
    s_waitcnt vmcnt(15)
    ds_read_b64_tr_b16 v[128:129], v23 offset:12288
    v_mfma_f32_16x16x32_bf16 v[88:91], v[144:147], v[176:179], v[88:91]
    buffer_load_dwordx4 v22, s[36:39], s94 offen offset:2048 lds
    v_mfma_f32_16x16x32_bf16 v[92:95], v[144:147], v[180:183], v[92:95]
    ds_read_b64_tr_b16 v[130:131], v23 offset:13056
    v_mfma_f32_16x16x32_bf16 v[116:119], v[144:147], v[124:127], v[116:119]
    ds_read_b64_tr_b16 v[132:133], v23 offset:12320
    v_mfma_f32_16x16x32_bf16 v[96:99], v[148:151], v[168:171], v[96:99]
    ds_read_b64_tr_b16 v[134:135], v23 offset:13088
    v_mfma_f32_16x16x32_bf16 v[100:103], v[148:151], v[172:175], v[100:103]
    s_waitcnt vmcnt(12)
    s_mov_b64 exec, 1
    buffer_store_dword v6, v5, s[48:51], s69 offen sc1
    s_mov_b64 exec, -1
    v_mfma_f32_16x16x32_bf16 v[104:107], v[148:151], v[176:179], v[104:107]
    ds_read_b64_tr_b16 v[136:137], v23 offset:12352
    v_mfma_f32_16x16x32_bf16 v[108:111], v[148:151], v[180:183], v[108:111]
    ds_read_b64_tr_b16 v[138:139], v23 offset:13120
    v_mfma_f32_16x16x32_bf16 v[120:123], v[148:151], v[124:127], v[120:123]
    s_waitcnt lgkmcnt(0)
    v_mfma_f32_16x16x32_bf16 v[64:67], v[128:131], v[152:155], v[64:67]
    ds_read_b128 v[168:171], v24 offset:704
    v_mfma_f32_16x16x32_bf16 v[68:71], v[128:131], v[156:159], v[68:71]
    v_mfma_f32_16x16x32_bf16 v[72:75], v[128:131], v[160:163], v[72:75]
    ds_read_b128 v[172:175], v24 offset:17600
    v_mfma_f32_16x16x32_bf16 v[76:79], v[128:131], v[164:167], v[76:79]
    ds_read_b128 v[176:179], v24 offset:34496
    v_mfma_f32_16x16x32_bf16 v[112:115], v[128:131], v[124:127], v[112:115]
    v_mfma_f32_16x16x32_bf16 v[80:83], v[132:135], v[152:155], v[80:83]
    ds_read_b128 v[180:183], v24 offset:51392
    v_mfma_f32_16x16x32_bf16 v[84:87], v[132:135], v[156:159], v[84:87]
    buffer_load_dword v232, v55, s[40:43], s66 offen
    v_mfma_f32_16x16x32_bf16 v[88:91], v[132:135], v[160:163], v[88:91]
    ds_read_b64_tr_b16 v[140:141], v23 offset:15360
    v_mfma_f32_16x16x32_bf16 v[92:95], v[132:135], v[164:167], v[92:95]
    ds_read_b64_tr_b16 v[142:143], v23 offset:16128
    v_mfma_f32_16x16x32_bf16 v[116:119], v[132:135], v[124:127], v[116:119]
    v_mfma_f32_16x16x32_bf16 v[96:99], v[136:139], v[152:155], v[96:99]
    ds_read_b64_tr_b16 v[144:145], v23 offset:15392
    v_mfma_f32_16x16x32_bf16 v[100:103], v[136:139], v[156:159], v[100:103]
    ds_read_b64_tr_b16 v[146:147], v23 offset:16160
    v_mfma_f32_16x16x32_bf16 v[104:107], v[136:139], v[160:163], v[104:107]
    ds_read_b64_tr_b16 v[148:149], v23 offset:15424
    v_mfma_f32_16x16x32_bf16 v[108:111], v[136:139], v[164:167], v[108:111]
    ds_read_b64_tr_b16 v[150:151], v23 offset:16192
    v_mfma_f32_16x16x32_bf16 v[120:123], v[136:139], v[124:127], v[120:123]
    s_waitcnt lgkmcnt(0)
    v_mfma_f32_16x16x32_bf16 v[64:67], v[140:143], v[168:171], v[64:67]
    ds_read_b128 v[152:155], v24 offset:768
    v_mfma_f32_16x16x32_bf16 v[68:71], v[140:143], v[172:175], v[68:71]
    ds_read_b128 v[156:159], v24 offset:17664
    v_mfma_f32_16x16x32_bf16 v[72:75], v[140:143], v[176:179], v[72:75]
    v_mfma_f32_16x16x32_bf16 v[76:79], v[140:143], v[180:183], v[76:79]
    ds_read_b128 v[160:163], v24 offset:34560
    v_mfma_f32_16x16x32_bf16 v[112:115], v[140:143], v[124:127], v[112:115]
    ds_read_b128 v[164:167], v24 offset:51456
    v_mfma_f32_16x16x32_bf16 v[80:83], v[144:147], v[168:171], v[80:83]
    v_mfma_f32_16x16x32_bf16 v[84:87], v[144:147], v[172:175], v[84:87]
    s_waitcnt vmcnt(11)
    ds_read_b64_tr_b16 v[128:129], v23 offset:0
    v_mfma_f32_16x16x32_bf16 v[88:91], v[144:147], v[176:179], v[88:91]
    ds_read_b64_tr_b16 v[130:131], v23 offset:768
    v_mfma_f32_16x16x32_bf16 v[92:95], v[144:147], v[180:183], v[92:95]
    v_mfma_f32_16x16x32_bf16 v[116:119], v[144:147], v[124:127], v[116:119]
    ds_read_b64_tr_b16 v[132:133], v23 offset:32
    v_mfma_f32_16x16x32_bf16 v[96:99], v[148:151], v[168:171], v[96:99]
    ds_read_b64_tr_b16 v[134:135], v23 offset:800
    v_mfma_f32_16x16x32_bf16 v[100:103], v[148:151], v[172:175], v[100:103]
    v_mfma_f32_16x16x32_bf16 v[104:107], v[148:151], v[176:179], v[104:107]
    ds_read_b64_tr_b16 v[136:137], v23 offset:64
    v_mfma_f32_16x16x32_bf16 v[108:111], v[148:151], v[180:183], v[108:111]
    ds_read_b64_tr_b16 v[138:139], v23 offset:832
    v_mfma_f32_16x16x32_bf16 v[120:123], v[148:151], v[124:127], v[120:123]
    s_waitcnt lgkmcnt(0)
    v_mfma_f32_16x16x32_bf16 v[64:67], v[128:131], v[152:155], v[64:67]
    ds_read_b128 v[168:171], v24 offset:832
    v_mfma_f32_16x16x32_bf16 v[68:71], v[128:131], v[156:159], v[68:71]
    s_add_u32 s52, s28, s59
    s_addc_u32 s53, s29, 0
    s_and_b32 s53, s53, 0xffff
    s_mov_b32 s54, 176128
    s_mov_b32 s55, 0x00020000
    s_lshl_b32 s64, s70, 11
    s_add_u32 s59, s59, s64
    v_mfma_f32_16x16x32_bf16 v[72:75], v[128:131], v[160:163], v[72:75]
    ds_read_b128 v[172:175], v24 offset:17728
    v_mfma_f32_16x16x32_bf16 v[76:79], v[128:131], v[164:167], v[76:79]
    ds_read_b128 v[176:179], v24 offset:34624
    v_mfma_f32_16x16x32_bf16 v[112:115], v[128:131], v[124:127], v[112:115]
    ds_read_b128 v[180:183], v24 offset:51520
    v_mfma_f32_16x16x32_bf16 v[80:83], v[132:135], v[152:155], v[80:83]
    s_add_u32 m0, s73, 18432
    s_mov_b32 s67, 49152
    buffer_load_dwordx4 v54, s[40:43], s67 offen offset:0 lds
    v_mfma_f32_16x16x32_bf16 v[84:87], v[132:135], v[156:159], v[84:87]
    s_waitcnt vmcnt(9)
    ds_read_b64_tr_b16 v[140:141], v23 offset:3072
    v_mfma_f32_16x16x32_bf16 v[88:91], v[132:135], v[160:163], v[88:91]
    v_mfma_f32_16x16x32_bf16 v[92:95], v[132:135], v[164:167], v[92:95]
    ds_read_b64_tr_b16 v[142:143], v23 offset:3840
    v_mfma_f32_16x16x32_bf16 v[116:119], v[132:135], v[124:127], v[116:119]
    ds_read_b64_tr_b16 v[144:145], v23 offset:3104
    v_mfma_f32_16x16x32_bf16 v[96:99], v[136:139], v[152:155], v[96:99]
    s_mov_b32 s67, 56320
    buffer_load_dwordx4 v54, s[40:43], s67 offen offset:1024 lds
    v_mfma_f32_16x16x32_bf16 v[100:103], v[136:139], v[156:159], v[100:103]
    ds_read_b64_tr_b16 v[146:147], v23 offset:3872
    v_mfma_f32_16x16x32_bf16 v[104:107], v[136:139], v[160:163], v[104:107]
    ds_read_b64_tr_b16 v[148:149], v23 offset:3136
    v_mfma_f32_16x16x32_bf16 v[108:111], v[136:139], v[164:167], v[108:111]
    ds_read_b64_tr_b16 v[150:151], v23 offset:3904
    v_mfma_f32_16x16x32_bf16 v[120:123], v[136:139], v[124:127], v[120:123]
    s_waitcnt lgkmcnt(0)
    v_mfma_f32_16x16x32_bf16 v[64:67], v[140:143], v[168:171], v[64:67]
    ds_read_b32 v184, v28 offset:0
    buffer_load_dwordx4 v[8:11], v47, s[32:35], s58 offen
    v_mfma_f32_16x16x32_bf16 v[68:71], v[140:143], v[172:175], v[68:71]
    ds_read_b128 v[152:155], v24 offset:896
    v_mfma_f32_16x16x32_bf16 v[72:75], v[140:143], v[176:179], v[72:75]
    ds_read_b32 v188, v28 offset:256
    ds_read_b128 v[156:159], v24 offset:17792
    v_mfma_f32_16x16x32_bf16 v[76:79], v[140:143], v[180:183], v[76:79]
    ds_read_b128 v[160:163], v24 offset:34688
    v_mfma_f32_16x16x32_bf16 v[112:115], v[140:143], v[124:127], v[112:115]
    ds_read_b32 v185, v28 offset:64
    buffer_load_dwordx4 v[12:15], v47, s[32:35], s58 offen offset:32
    v_mfma_f32_16x16x32_bf16 v[80:83], v[144:147], v[168:171], v[80:83]
    ds_read_b128 v[164:167], v24 offset:51584
    v_mfma_f32_16x16x32_bf16 v[84:87], v[144:147], v[172:175], v[84:87]
    ds_read_b32 v189, v28 offset:320
    s_waitcnt vmcnt(9)
    ds_read_b64_tr_b16 v[128:129], v23 offset:6144
    v_mfma_f32_16x16x32_bf16 v[88:91], v[144:147], v[176:179], v[88:91]
    ds_read_b32 v186, v28 offset:128
    v_mfma_f32_16x16x32_bf16 v[92:95], v[144:147], v[180:183], v[92:95]
    s_add_u32 m0, s73, 12288
    s_mov_b32 s67, 0
    buffer_load_dwordx4 v54, s[40:43], s67 offen offset:0 lds
    ds_read_b64_tr_b16 v[130:131], v23 offset:6912
    v_mfma_f32_16x16x32_bf16 v[116:119], v[144:147], v[124:127], v[116:119]
    ds_read_b32 v190, v28 offset:384
    v_mfma_f32_16x16x32_bf16 v[96:99], v[148:151], v[168:171], v[96:99]
    ds_read_b64_tr_b16 v[132:133], v23 offset:6176
    ds_read_b64_tr_b16 v[134:135], v23 offset:6944
    v_mfma_f32_16x16x32_bf16 v[100:103], v[148:151], v[172:175], v[100:103]
    ds_read_b32 v187, v28 offset:192
    v_mfma_f32_16x16x32_bf16 v[104:107], v[148:151], v[176:179], v[104:107]
    s_mov_b32 s67, 7168
    buffer_load_dwordx4 v54, s[40:43], s67 offen offset:1024 lds
    ds_read_b64_tr_b16 v[136:137], v23 offset:6208
    v_mfma_f32_16x16x32_bf16 v[108:111], v[148:151], v[180:183], v[108:111]
    ds_read_b32 v191, v28 offset:448
    v_mfma_f32_16x16x32_bf16 v[120:123], v[148:151], v[124:127], v[120:123]
    ds_read_b64_tr_b16 v[138:139], v23 offset:6976
    s_waitcnt lgkmcnt(0)
    v_mfma_f32_16x16x32_bf16 v[64:67], v[128:131], v[152:155], v[64:67]
    ds_read_b128 v[168:171], v24 offset:960
    v_mfma_f32_16x16x32_bf16 v[68:71], v[128:131], v[156:159], v[68:71]
    s_add_u32 m0, s73, 14336
    s_mov_b32 s67, 16384
    buffer_load_dwordx4 v54, s[40:43], s67 offen offset:0 lds
    v_mfma_f32_16x16x32_bf16 v[72:75], v[128:131], v[160:163], v[72:75]
    ds_read_b128 v[172:175], v24 offset:17856
    v_mfma_f32_16x16x32_bf16 v[76:79], v[128:131], v[164:167], v[76:79]
    ds_read_b128 v[176:179], v24 offset:34752
    v_mfma_f32_16x16x32_bf16 v[112:115], v[128:131], v[124:127], v[112:115]
    v_mfma_f32_16x16x32_bf16 v[80:83], v[132:135], v[152:155], v[80:83]
    ds_read_b128 v[180:183], v24 offset:51648
    v_mfma_f32_16x16x32_bf16 v[84:87], v[132:135], v[156:159], v[84:87]
    s_mov_b32 s67, 23552
    buffer_load_dwordx4 v54, s[40:43], s67 offen offset:1024 lds
    v_mfma_f32_16x16x32_bf16 v[88:91], v[132:135], v[160:163], v[88:91]
    s_waitcnt vmcnt(10)
    ds_read_b64_tr_b16 v[140:141], v23 offset:9216
    v_mfma_f32_16x16x32_bf16 v[92:95], v[132:135], v[164:167], v[92:95]
    ds_read_b64_tr_b16 v[142:143], v23 offset:9984
    v_mfma_f32_16x16x32_bf16 v[116:119], v[132:135], v[124:127], v[116:119]
    v_mfma_f32_16x16x32_bf16 v[96:99], v[136:139], v[152:155], v[96:99]
    ds_read_b64_tr_b16 v[144:145], v23 offset:9248
    v_mfma_f32_16x16x32_bf16 v[100:103], v[136:139], v[156:159], v[100:103]
    ds_read_b64_tr_b16 v[146:147], v23 offset:10016
    v_mfma_f32_16x16x32_bf16 v[104:107], v[136:139], v[160:163], v[104:107]
    ds_read_b64_tr_b16 v[148:149], v23 offset:9280
    v_mfma_f32_16x16x32_bf16 v[108:111], v[136:139], v[164:167], v[108:111]
    ds_read_b64_tr_b16 v[150:151], v23 offset:10048
    v_mfma_f32_16x16x32_bf16 v[120:123], v[136:139], v[124:127], v[120:123]
    s_waitcnt lgkmcnt(0)
    s_waitcnt lgkmcnt(0)
    s_mov_b32 s97, 0
    s_cmp_lg_u32 s61, 3
    s_cbranch_scc1 L_nolook
    s_add_u32 s64, s98, 64
    s_add_u32 s65, s98, 96
    s_load_dwordx16 s[4:19], s[28:29], s98 glc
    s_load_dwordx8 s[20:27], s[28:29], s64 glc
    s_load_dwordx8 s[84:91], s[28:29], s65 glc
L_nolook:
    v_mfma_f32_16x16x32_bf16 v[64:67], v[140:143], v[168:171], v[64:67]
    s_add_u32 m0, s73, 16384
    s_mov_b32 s67, 32768
    buffer_load_dwordx4 v54, s[40:43], s67 offen offset:0 lds
    v_mfma_f32_16x16x32_bf16 v[68:71], v[140:143], v[172:175], v[68:71]
    v_mfma_f32_16x16x32_bf16 v[72:75], v[140:143], v[176:179], v[72:75]
    v_mfma_f32_16x16x32_bf16 v[76:79], v[140:143], v[180:183], v[76:79]
    v_mfma_f32_16x16x32_bf16 v[112:115], v[140:143], v[124:127], v[112:115]
    v_mfma_f32_16x16x32_bf16 v[80:83], v[144:147], v[168:171], v[80:83]
    v_mfma_f32_16x16x32_bf16 v[84:87], v[144:147], v[172:175], v[84:87]
    v_mfma_f32_16x16x32_bf16 v[88:91], v[144:147], v[176:179], v[88:91]
    s_mov_b32 s67, 39936
    buffer_load_dwordx4 v54, s[40:43], s67 offen offset:1024 lds
    v_mfma_f32_16x16x32_bf16 v[92:95], v[144:147], v[180:183], v[92:95]
    v_mfma_f32_16x16x32_bf16 v[116:119], v[144:147], v[124:127], v[116:119]
    v_mfma_f32_16x16x32_bf16 v[96:99], v[148:151], v[168:171], v[96:99]
    v_mfma_f32_16x16x32_bf16 v[100:103], v[148:151], v[172:175], v[100:103]
    v_mfma_f32_16x16x32_bf16 v[104:107], v[148:151], v[176:179], v[104:107]
    v_mfma_f32_16x16x32_bf16 v[108:111], v[148:151], v[180:183], v[108:111]
    v_mfma_f32_16x16x32_bf16 v[120:123], v[148:151], v[124:127], v[120:123]
    s_barrier
    v_mov_b32 v192, s81
    v_mov_b32 v193, s81
    v_mul_f32 v188, s81, v188
    v_mul_f32 v189, s81, v189
    v_mul_f32 v190, s81, v190
    v_mul_f32 v191, s81, v191
    s_add_u32 s65, s59, 0
    s_cmp_gt_u32 s71, 0
    s_cselect_b32 s65, s65, 1073741824
    v_pk_fma_f32 v[64:65], v[112:113], v[184:185], v[64:65] op_sel:[0,0,0] op_sel_hi:[1,0,1] neg_lo:[0,1,0] neg_hi:[0,1,0]
    v_pk_mul_f32 v[64:65], v[64:65], v[188:189] op_sel:[0,0] op_sel_hi:[1,0]
    v_pk_fma_f32 v[66:67], v[114:115], v[184:185], v[66:67] op_sel:[0,0,0] op_sel_hi:[1,0,1] neg_lo:[0,1,0] neg_hi:[0,1,0]
    v_pk_mul_f32 v[66:67], v[66:67], v[188:189] op_sel:[0,0] op_sel_hi:[1,0]
    v_exp_f32 v224, v64
    v_exp_f32 v225, v65
    v_exp_f32 v226, v66
    v_exp_f32 v227, v67
    s_add_u32 m0, s73, 0
    s_mov_b32 s67, 65536
    buffer_load_dwordx4 v54, s[40:43], s67 offen offset:0 lds
    s_mov_b32 s67, 72704
    buffer_load_dwordx4 v54, s[40:43], s67 offen offset:1024 lds
    v_pk_fma_f32 v[224:225], v[224:225], v[192:193], v[192:193]
    v_pk_fma_f32 v[226:227], v[226:227], v[192:193], v[192:193]
    v_rcp_f32 v224, v224
    v_rcp_f32 v225, v225
    v_rcp_f32 v226, v226
    v_rcp_f32 v227, v227
    v_pk_mul_f32 v[64:65], v[64:65], v[224:225]
    v_pk_mul_f32 v[66:67], v[66:67], v[226:227]
    v_cvt_pk_bf16_f32 v216, v64, v65
    v_cvt_pk_bf16_f32 v217, v66, v67
    v_pk_fma_f32 v[68:69], v[112:113], v[184:185], v[68:69] op_sel:[0,1,0] op_sel_hi:[1,1,1] neg_lo:[0,1,0] neg_hi:[0,1,0]
    v_pk_mul_f32 v[68:69], v[68:69], v[188:189] op_sel:[0,1] op_sel_hi:[1,1]
    v_pk_fma_f32 v[70:71], v[114:115], v[184:185], v[70:71] op_sel:[0,1,0] op_sel_hi:[1,1,1] neg_lo:[0,1,0] neg_hi:[0,1,0]
    v_pk_mul_f32 v[70:71], v[70:71], v[188:189] op_sel:[0,1] op_sel_hi:[1,1]
    v_exp_f32 v228, v68
    v_exp_f32 v229, v69
    v_exp_f32 v230, v70
    v_exp_f32 v231, v71
    s_add_u32 m0, s73, 2048
    s_mov_b32 s67, 81920
    buffer_load_dwordx4 v54, s[40:43], s67 offen offset:0 lds
    s_mov_b32 s67, 89088
    buffer_load_dwordx4 v54, s[40:43], s67 offen offset:1024 lds
    v_pk_fma_f32 v[228:229], v[228:229], v[192:193], v[192:193]
    v_pk_fma_f32 v[230:231], v[230:231], v[192:193], v[192:193]
    v_rcp_f32 v228, v228
    v_rcp_f32 v229, v229
    v_rcp_f32 v230, v230
    v_rcp_f32 v231, v231
    v_pk_mul_f32 v[68:69], v[68:69], v[228:229]
    v_pk_mul_f32 v[70:71], v[70:71], v[230:231]
    v_cvt_pk_bf16_f32 v218, v68, v69
    v_cvt_pk_bf16_f32 v219, v70, v71
    s_nop 0
    v_permlane16_swap_b32 v216, v218
    v_permlane16_swap_b32 v217, v219
    buffer_store_dwordx4 v[216:219], v7, s[48:51], s65 offen offset:0 sc1
    v_pk_fma_f32 v[72:73], v[112:113], v[186:187], v[72:73] op_sel:[0,0,0] op_sel_hi:[1,0,1] neg_lo:[0,1,0] neg_hi:[0,1,0]
    v_pk_mul_f32 v[72:73], v[72:73], v[190:191] op_sel:[0,0] op_sel_hi:[1,0]
    v_pk_fma_f32 v[74:75], v[114:115], v[186:187], v[74:75] op_sel:[0,0,0] op_sel_hi:[1,0,1] neg_lo:[0,1,0] neg_hi:[0,1,0]
    v_pk_mul_f32 v[74:75], v[74:75], v[190:191] op_sel:[0,0] op_sel_hi:[1,0]
    v_exp_f32 v224, v72
    v_exp_f32 v225, v73
    v_exp_f32 v226, v74
    v_exp_f32 v227, v75
    s_add_u32 m0, s73, 4096
    s_mov_b32 s67, 98304
    buffer_load_dwordx4 v54, s[40:43], s67 offen offset:0 lds
    s_mov_b32 s67, 105472
    buffer_load_dwordx4 v54, s[40:43], s67 offen offset:1024 lds
    v_pk_fma_f32 v[224:225], v[224:225], v[192:193], v[192:193]
    v_pk_fma_f32 v[226:227], v[226:227], v[192:193], v[192:193]
    v_rcp_f32 v224, v224
    v_rcp_f32 v225, v225
    v_rcp_f32 v226, v226
    v_rcp_f32 v227, v227
    v_pk_mul_f32 v[72:73], v[72:73], v[224:225]
    v_pk_mul_f32 v[74:75], v[74:75], v[226:227]
    v_cvt_pk_bf16_f32 v220, v72, v73
    v_cvt_pk_bf16_f32 v221, v74, v75
    v_pk_fma_f32 v[76:77], v[112:113], v[186:187], v[76:77] op_sel:[0,1,0] op_sel_hi:[1,1,1] neg_lo:[0,1,0] neg_hi:[0,1,0]
    v_pk_mul_f32 v[76:77], v[76:77], v[190:191] op_sel:[0,1] op_sel_hi:[1,1]
    v_pk_fma_f32 v[78:79], v[114:115], v[186:187], v[78:79] op_sel:[0,1,0] op_sel_hi:[1,1,1] neg_lo:[0,1,0] neg_hi:[0,1,0]
    v_pk_mul_f32 v[78:79], v[78:79], v[190:191] op_sel:[0,1] op_sel_hi:[1,1]
    v_exp_f32 v228, v76
    v_exp_f32 v229, v77
    v_exp_f32 v230, v78
    v_exp_f32 v231, v79
    v_pk_fma_f32 v[228:229], v[228:229], v[192:193], v[192:193]
    v_pk_fma_f32 v[230:231], v[230:231], v[192:193], v[192:193]
    v_rcp_f32 v228, v228
    v_rcp_f32 v229, v229
    v_rcp_f32 v230, v230
    v_rcp_f32 v231, v231
    v_pk_mul_f32 v[76:77], v[76:77], v[228:229]
    v_pk_mul_f32 v[78:79], v[78:79], v[230:231]
    v_cvt_pk_bf16_f32 v222, v76, v77
    v_cvt_pk_bf16_f32 v223, v78, v79
    s_nop 0
    v_permlane16_swap_b32 v220, v222
    v_permlane16_swap_b32 v221, v223
    buffer_store_dwordx4 v[220:223], v7, s[48:51], s65 offen offset:1024 sc1
    s_cmp_lg_u32 s61, 3
    s_cbranch_scc1 L_u1
    s_cmp_eq_u32 s97, 1
    s_cbranch_scc1 L_u1
    s_waitcnt lgkmcnt(0)
    s_xor_b64 s[4:5], s[4:5], s[62:63]
    s_xor_b64 s[6:7], s[6:7], s[62:63]
    s_xor_b64 s[8:9], s[8:9], s[62:63]
    s_xor_b64 s[10:11], s[10:11], s[62:63]
    s_xor_b64 s[12:13], s[12:13], s[62:63]
    s_xor_b64 s[14:15], s[14:15], s[62:63]
    s_xor_b64 s[16:17], s[16:17], s[62:63]
    s_xor_b64 s[18:19], s[18:19], s[62:63]
    s_xor_b64 s[20:21], s[20:21], s[62:63]
    s_xor_b64 s[22:23], s[22:23], s[62:63]
    s_xor_b64 s[24:25], s[24:25], s[62:63]
    s_xor_b64 s[26:27], s[26:27], s[62:63]
    s_xor_b64 s[84:85], s[84:85], s[62:63]
    s_xor_b64 s[86:87], s[86:87], s[62:63]
    s_xor_b64 s[88:89], s[88:89], s[62:63]
    s_xor_b64 s[90:91], s[90:91], s[62:63]
    s_or_b64 s[4:5], s[4:5], s[6:7]
    s_or_b64 s[4:5], s[4:5], s[8:9]
    s_or_b64 s[4:5], s[4:5], s[10:11]
    s_or_b64 s[4:5], s[4:5], s[12:13]
    s_or_b64 s[4:5], s[4:5], s[14:15]
    s_or_b64 s[4:5], s[4:5], s[16:17]
    s_or_b64 s[4:5], s[4:5], s[18:19]
    s_or_b64 s[4:5], s[4:5], s[20:21]
    s_or_b64 s[4:5], s[4:5], s[22:23]
    s_or_b64 s[4:5], s[4:5], s[24:25]
    s_or_b64 s[4:5], s[4:5], s[26:27]
    s_or_b64 s[4:5], s[4:5], s[84:85]
    s_or_b64 s[4:5], s[4:5], s[86:87]
    s_or_b64 s[4:5], s[4:5], s[88:89]
    s_or_b64 s[4:5], s[4:5], s[90:91]
    s_cbranch_scc0 L_fxok
    s_mov_b32 s3, 0x40000
    s_branch Lp0x_3
Lpollx_1:
    s_sleep 2
Lp0x_3:
    s_load_dwordx16 s[4:19], s[28:29], s98 glc
    s_waitcnt lgkmcnt(0)
    s_xor_b64 s[4:5], s[4:5], s[62:63]
    s_xor_b64 s[6:7], s[6:7], s[62:63]
    s_xor_b64 s[8:9], s[8:9], s[62:63]
    s_xor_b64 s[10:11], s[10:11], s[62:63]
    s_xor_b64 s[12:13], s[12:13], s[62:63]
    s_xor_b64 s[14:15], s[14:15], s[62:63]
    s_xor_b64 s[16:17], s[16:17], s[62:63]
    s_xor_b64 s[18:19], s[18:19], s[62:63]
    s_or_b64 s[4:5], s[4:5], s[6:7]
    s_or_b64 s[4:5], s[4:5], s[8:9]
    s_or_b64 s[4:5], s[4:5], s[10:11]
    s_or_b64 s[4:5], s[4:5], s[12:13]
    s_or_b64 s[4:5], s[4:5], s[14:15]
    s_or_b64 s[4:5], s[4:5], s[16:17]
    s_or_b64 s[4:5], s[4:5], s[18:19]
    s_cbranch_scc1 Lpnx_4
    s_add_u32 s64, s98, 64
    s_load_dwordx16 s[4:19], s[28:29], s64 glc
    s_waitcnt lgkmcnt(0)
    s_xor_b64 s[4:5], s[4:5], s[62:63]
    s_xor_b64 s[6:7], s[6:7], s[62:63]
    s_xor_b64 s[8:9], s[8:9], s[62:63]
    s_xor_b64 s[10:11], s[10:11], s[62:63]
    s_xor_b64 s[12:13], s[12:13], s[62:63]
    s_xor_b64 s[14:15], s[14:15], s[62:63]
    s_xor_b64 s[16:17], s[16:17], s[62:63]
    s_xor_b64 s[18:19], s[18:19], s[62:63]
    s_or_b64 s[4:5], s[4:5], s[6:7]
    s_or_b64 s[4:5], s[4:5], s[8:9]
    s_or_b64 s[4:5], s[4:5], s[10:11]
    s_or_b64 s[4:5], s[4:5], s[12:13]
    s_or_b64 s[4:5], s[4:5], s[14:15]
    s_or_b64 s[4:5], s[4:5], s[16:17]
    s_or_b64 s[4:5], s[4:5], s[18:19]
Lpnx_4:
    s_cbranch_scc0 Lpdx_2
    s_sub_u32 s3, s3, 1
    s_cbranch_scc0 Lpollx_1
Lpdx_2:
L_fxok:
    s_lshl_b32 s64, s60, 13
    s_add_u32 s65, s64, 4096
    s_mov_b32 m0, 152544
    s_nop 0
    buffer_load_dwordx4 v7, s[48:51], s64 offen offset:0 sc1 lds
    buffer_load_dwordx4 v7, s[48:51], s64 offen offset:1024 sc1 lds
    buffer_load_dwordx4 v7, s[48:51], s64 offen offset:2048 sc1 lds
    buffer_load_dwordx4 v7, s[48:51], s64 offen offset:3072 sc1 lds
    s_mov_b32 m0, 157152
    s_nop 0
    buffer_load_dwordx4 v7, s[48:51], s65 offen offset:0 sc1 lds
    buffer_load_dwordx4 v7, s[48:51], s65 offen offset:1024 sc1 lds
    buffer_load_dwordx4 v7, s[48:51], s65 offen offset:2048 sc1 lds
    buffer_load_dwordx4 v7, s[48:51], s65 offen offset:3072 sc1 lds
L_u1:
    s_add_u32 s65, s59, 2048
    s_cmp_gt_u32 s71, 1
    s_cselect_b32 s65, s65, 1073741824
    v_pk_fma_f32 v[80:81], v[116:117], v[184:185], v[80:81] op_sel:[0,0,0] op_sel_hi:[1,0,1] neg_lo:[0,1,0] neg_hi:[0,1,0]
    v_pk_mul_f32 v[80:81], v[80:81], v[188:189] op_sel:[0,0] op_sel_hi:[1,0]
    v_pk_fma_f32 v[82:83], v[118:119], v[184:185], v[82:83] op_sel:[0,0,0] op_sel_hi:[1,0,1] neg_lo:[0,1,0] neg_hi:[0,1,0]
    v_pk_mul_f32 v[82:83], v[82:83], v[188:189] op_sel:[0,0] op_sel_hi:[1,0]
    v_exp_f32 v224, v80
    v_exp_f32 v225, v81
    v_exp_f32 v226, v82
    v_exp_f32 v227, v83
    s_add_u32 m0, s73, 6144
    s_mov_b32 s67, 114688
    buffer_load_dwordx4 v54, s[40:43], s67 offen offset:0 lds
    s_mov_b32 s67, 121856
    buffer_load_dwordx4 v54, s[40:43], s67 offen offset:1024 lds
    v_pk_fma_f32 v[224:225], v[224:225], v[192:193], v[192:193]
    v_pk_fma_f32 v[226:227], v[226:227], v[192:193], v[192:193]
    v_rcp_f32 v224, v224
    v_rcp_f32 v225, v225
    v_rcp_f32 v226, v226
    v_rcp_f32 v227, v227
    v_pk_mul_f32 v[80:81], v[80:81], v[224:225]
    v_pk_mul_f32 v[82:83], v[82:83], v[226:227]
    v_cvt_pk_bf16_f32 v216, v80, v81
    v_cvt_pk_bf16_f32 v217, v82, v83
    v_pk_fma_f32 v[84:85], v[116:117], v[184:185], v[84:85] op_sel:[0,1,0] op_sel_hi:[1,1,1] neg_lo:[0,1,0] neg_hi:[0,1,0]
    v_pk_mul_f32 v[84:85], v[84:85], v[188:189] op_sel:[0,1] op_sel_hi:[1,1]
    v_pk_fma_f32 v[86:87], v[118:119], v[184:185], v[86:87] op_sel:[0,1,0] op_sel_hi:[1,1,1] neg_lo:[0,1,0] neg_hi:[0,1,0]
    v_pk_mul_f32 v[86:87], v[86:87], v[188:189] op_sel:[0,1] op_sel_hi:[1,1]
    v_exp_f32 v228, v84
    v_exp_f32 v229, v85
    v_exp_f32 v230, v86
    v_exp_f32 v231, v87
    s_add_u32 m0, s73, 8192
    s_mov_b32 s67, 131072
    buffer_load_dwordx4 v54, s[40:43], s67 offen offset:0 lds
    s_mov_b32 s67, 138240
    buffer_load_dwordx4 v54, s[40:43], s67 offen offset:1024 lds
    v_pk_fma_f32 v[228:229], v[228:229], v[192:193], v[192:193]
    v_pk_fma_f32 v[230:231], v[230:231], v[192:193], v[192:193]
    v_rcp_f32 v228, v228
    v_rcp_f32 v229, v229
    v_rcp_f32 v230, v230
    v_rcp_f32 v231, v231
    v_pk_mul_f32 v[84:85], v[84:85], v[228:229]
    v_pk_mul_f32 v[86:87], v[86:87], v[230:231]
    v_cvt_pk_bf16_f32 v218, v84, v85
    v_cvt_pk_bf16_f32 v219, v86, v87
    s_nop 0
    v_permlane16_swap_b32 v216, v218
    v_permlane16_swap_b32 v217, v219
    buffer_store_dwordx4 v[216:219], v7, s[48:51], s65 offen offset:0 sc1
    v_pk_fma_f32 v[88:89], v[116:117], v[186:187], v[88:89] op_sel:[0,0,0] op_sel_hi:[1,0,1] neg_lo:[0,1,0] neg_hi:[0,1,0]
    v_pk_mul_f32 v[88:89], v[88:89], v[190:191] op_sel:[0,0] op_sel_hi:[1,0]
    v_pk_fma_f32 v[90:91], v[118:119], v[186:187], v[90:91] op_sel:[0,0,0] op_sel_hi:[1,0,1] neg_lo:[0,1,0] neg_hi:[0,1,0]
    v_pk_mul_f32 v[90:91], v[90:91], v[190:191] op_sel:[0,0] op_sel_hi:[1,0]
    v_exp_f32 v224, v88
    v_exp_f32 v225, v89
    v_exp_f32 v226, v90
    v_exp_f32 v227, v91
    s_add_u32 m0, s73, 10240
    s_mov_b32 s67, 147456
    buffer_load_dwordx4 v54, s[40:43], s67 offen offset:0 lds
    s_mov_b32 s67, 154624
    buffer_load_dwordx4 v54, s[40:43], s67 offen offset:1024 lds
    v_pk_fma_f32 v[224:225], v[224:225], v[192:193], v[192:193]
    v_pk_fma_f32 v[226:227], v[226:227], v[192:193], v[192:193]
    v_rcp_f32 v224, v224
    v_rcp_f32 v225, v225
    v_rcp_f32 v226, v226
    v_rcp_f32 v227, v227
    v_pk_mul_f32 v[88:89], v[88:89], v[224:225]
    v_pk_mul_f32 v[90:91], v[90:91], v[226:227]
    v_cvt_pk_bf16_f32 v220, v88, v89
    v_cvt_pk_bf16_f32 v221, v90, v91
    v_pk_fma_f32 v[92:93], v[116:117], v[186:187], v[92:93] op_sel:[0,1,0] op_sel_hi:[1,1,1] neg_lo:[0,1,0] neg_hi:[0,1,0]
    v_pk_mul_f32 v[92:93], v[92:93], v[190:191] op_sel:[0,1] op_sel_hi:[1,1]
    v_pk_fma_f32 v[94:95], v[118:119], v[186:187], v[94:95] op_sel:[0,1,0] op_sel_hi:[1,1,1] neg_lo:[0,1,0] neg_hi:[0,1,0]
    v_pk_mul_f32 v[94:95], v[94:95], v[190:191] op_sel:[0,1] op_sel_hi:[1,1]
    v_exp_f32 v228, v92
    v_exp_f32 v229, v93
    v_exp_f32 v230, v94
    v_exp_f32 v231, v95
    v_pk_fma_f32 v[228:229], v[228:229], v[192:193], v[192:193]
    v_pk_fma_f32 v[230:231], v[230:231], v[192:193], v[192:193]
    v_rcp_f32 v228, v228
    v_rcp_f32 v229, v229
    v_rcp_f32 v230, v230
    v_rcp_f32 v231, v231
    v_pk_mul_f32 v[92:93], v[92:93], v[228:229]
    v_pk_mul_f32 v[94:95], v[94:95], v[230:231]
    v_cvt_pk_bf16_f32 v222, v92, v93
    v_cvt_pk_bf16_f32 v223, v94, v95
    s_nop 0
    v_permlane16_swap_b32 v220, v222
    v_permlane16_swap_b32 v221, v223
    buffer_store_dwordx4 v[220:223], v7, s[48:51], s65 offen offset:1024 sc1
    s_cmp_lg_u32 s61, 3
    s_cbranch_scc1 L_u2
    s_mov_b32 s65, 1073741824
    buffer_store_dword v5, v5, s[48:51], s65 offen
    buffer_store_dword v5, v5, s[48:51], s65 offen
    s_branch L_u2done
L_u2:
    s_add_u32 s65, s59, 4096
    s_cmp_gt_u32 s71, 2
    s_cselect_b32 s65, s65, 1073741824
    v_pk_fma_f32 v[96:97], v[120:121], v[184:185], v[96:97] op_sel:[0,0,0] op_sel_hi:[1,0,1] neg_lo:[0,1,0] neg_hi:[0,1,0]
    v_pk_mul_f32 v[96:97], v[96:97], v[188:189] op_sel:[0,0] op_sel_hi:[1,0]
    v_pk_fma_f32 v[98:99], v[122:123], v[184:185], v[98:99] op_sel:[0,0,0] op_sel_hi:[1,0,1] neg_lo:[0,1,0] neg_hi:[0,1,0]
    v_pk_mul_f32 v[98:99], v[98:99], v[188:189] op_sel:[0,0] op_sel_hi:[1,0]
    v_exp_f32 v224, v96
    v_exp_f32 v225, v97
    v_exp_f32 v226, v98
    v_exp_f32 v227, v99
    v_pk_fma_f32 v[224:225], v[224:225], v[192:193], v[192:193]
    v_pk_fma_f32 v[226:227], v[226:227], v[192:193], v[192:193]
    v_rcp_f32 v224, v224
    v_rcp_f32 v225, v225
    v_rcp_f32 v226, v226
    v_rcp_f32 v227, v227
    v_pk_mul_f32 v[96:97], v[96:97], v[224:225]
    v_pk_mul_f32 v[98:99], v[98:99], v[226:227]
    v_cvt_pk_bf16_f32 v216, v96, v97
    v_cvt_pk_bf16_f32 v217, v98, v99
    v_pk_fma_f32 v[100:101], v[120:121], v[184:185], v[100:101] op_sel:[0,1,0] op_sel_hi:[1,1,1] neg_lo:[0,1,0] neg_hi:[0,1,0]
    v_pk_mul_f32 v[100:101], v[100:101], v[188:189] op_sel:[0,1] op_sel_hi:[1,1]
    v_pk_fma_f32 v[102:103], v[122:123], v[184:185], v[102:103] op_sel:[0,1,0] op_sel_hi:[1,1,1] neg_lo:[0,1,0] neg_hi:[0,1,0]
    v_pk_mul_f32 v[102:103], v[102:103], v[188:189] op_sel:[0,1] op_sel_hi:[1,1]
    v_exp_f32 v228, v100
    v_exp_f32 v229, v101
    v_exp_f32 v230, v102
    v_exp_f32 v231, v103
    v_pk_fma_f32 v[228:229], v[228:229], v[192:193], v[192:193]
    v_pk_fma_f32 v[230:231], v[230:231], v[192:193], v[192:193]
    v_rcp_f32 v228, v228
    v_rcp_f32 v229, v229
    v_rcp_f32 v230, v230
    v_rcp_f32 v231, v231
    v_pk_mul_f32 v[100:101], v[100:101], v[228:229]
    v_pk_mul_f32 v[102:103], v[102:103], v[230:231]
    v_cvt_pk_bf16_f32 v218, v100, v101
    v_cvt_pk_bf16_f32 v219, v102, v103
    s_nop 0
    v_permlane16_swap_b32 v216, v218
    v_permlane16_swap_b32 v217, v219
    buffer_store_dwordx4 v[216:219], v7, s[48:51], s65 offen offset:0 sc1
    v_pk_fma_f32 v[104:105], v[120:121], v[186:187], v[104:105] op_sel:[0,0,0] op_sel_hi:[1,0,1] neg_lo:[0,1,0] neg_hi:[0,1,0]
    v_pk_mul_f32 v[104:105], v[104:105], v[190:191] op_sel:[0,0] op_sel_hi:[1,0]
    v_pk_fma_f32 v[106:107], v[122:123], v[186:187], v[106:107] op_sel:[0,0,0] op_sel_hi:[1,0,1] neg_lo:[0,1,0] neg_hi:[0,1,0]
    v_pk_mul_f32 v[106:107], v[106:107], v[190:191] op_sel:[0,0] op_sel_hi:[1,0]
    v_exp_f32 v224, v104
    v_exp_f32 v225, v105
    v_exp_f32 v226, v106
    v_exp_f32 v227, v107
    v_pk_fma_f32 v[224:225], v[224:225], v[192:193], v[192:193]
    v_pk_fma_f32 v[226:227], v[226:227], v[192:193], v[192:193]
    v_rcp_f32 v224, v224
    v_rcp_f32 v225, v225
    v_rcp_f32 v226, v226
    v_rcp_f32 v227, v227
    v_pk_mul_f32 v[104:105], v[104:105], v[224:225]
    v_pk_mul_f32 v[106:107], v[106:107], v[226:227]
    v_cvt_pk_bf16_f32 v220, v104, v105
    v_cvt_pk_bf16_f32 v221, v106, v107
    v_pk_fma_f32 v[108:109], v[120:121], v[186:187], v[108:109] op_sel:[0,1,0] op_sel_hi:[1,1,1] neg_lo:[0,1,0] neg_hi:[0,1,0]
    v_pk_mul_f32 v[108:109], v[108:109], v[190:191] op_sel:[0,1] op_sel_hi:[1,1]
    v_pk_fma_f32 v[110:111], v[122:123], v[186:187], v[110:111] op_sel:[0,1,0] op_sel_hi:[1,1,1] neg_lo:[0,1,0] neg_hi:[0,1,0]
    v_pk_mul_f32 v[110:111], v[110:111], v[190:191] op_sel:[0,1] op_sel_hi:[1,1]
    v_exp_f32 v228, v108
    v_exp_f32 v229, v109
    v_exp_f32 v230, v110
    v_exp_f32 v231, v111
    v_pk_fma_f32 v[228:229], v[228:229], v[192:193], v[192:193]
    v_pk_fma_f32 v[230:231], v[230:231], v[192:193], v[192:193]
    v_rcp_f32 v228, v228
    v_rcp_f32 v229, v229
    v_rcp_f32 v230, v230
    v_rcp_f32 v231, v231
    v_pk_mul_f32 v[108:109], v[108:109], v[228:229]
    v_pk_mul_f32 v[110:111], v[110:111], v[230:231]
    v_cvt_pk_bf16_f32 v222, v108, v109
    v_cvt_pk_bf16_f32 v223, v110, v111
    s_nop 0
    v_permlane16_swap_b32 v220, v222
    v_permlane16_swap_b32 v221, v223
    buffer_store_dwordx4 v[220:223], v7, s[48:51], s65 offen offset:1024 sc1
L_u2done:
    v_mov_b32 v88, 0
    v_mov_b32 v89, 0
    v_mov_b32 v90, 0
    v_mov_b32 v91, 0
    s_bitcmp1_b32 s95, 0
    s_cbranch_scc1 L_kodd
    s_mov_b32 vcc_lo, 0xaaaaaaaa
    s_mov_b32 vcc_hi, 0xaaaaaaaa
    s_mov_b64 exec, 0x3fffffff
    ds_write_b128 v18, v[88:91]
    s_mov_b64 exec, -1
    v_cndmask_b32 v68, v240, v241, vcc
    v_cvt_pk_bf16_f32 v72, v241, v241
    v_cvt_pk_bf16_f32 v73, v241, v68
    v_cvt_pk_bf16_f32 v74, v240, v240
    v_cvt_pk_bf16_f32 v75, v240, v240
    ds_write_b128 v42, v[72:75] offset:512
    v_cvt_pk_bf16_f32 v76, v241, v241
    v_cvt_pk_bf16_f32 v77, v241, v241
    v_cvt_pk_bf16_f32 v78, v68, v240
    v_cvt_pk_bf16_f32 v79, v240, v240
    ds_write_b128 v42, v[76:79] offset:4672
    v_cndmask_b32 v69, v242, v243, vcc
    v_cvt_pk_bf16_f32 v80, v243, v243
    v_cvt_pk_bf16_f32 v81, v243, v69
    v_cvt_pk_bf16_f32 v82, v242, v242
    v_cvt_pk_bf16_f32 v83, v242, v242
    ds_write_b128 v42, v[80:83] offset:0
    v_cvt_pk_bf16_f32 v84, v243, v243
    v_cvt_pk_bf16_f32 v85, v243, v243
    v_cvt_pk_bf16_f32 v86, v69, v242
    v_cvt_pk_bf16_f32 v87, v242, v242
    ds_write_b128 v42, v[84:87] offset:4160
    s_branch L_kdone
L_kodd:
    v_cvt_pk_bf16_f32 v72, v246, v246
    v_cvt_pk_bf16_f32 v73, v245, v245
    v_cvt_pk_bf16_f32 v74, v245, v244
    v_cvt_pk_bf16_f32 v75, v244, v244
    ds_write_b128 v43, v[72:75] offset:0
    v_cvt_pk_bf16_f32 v76, v246, v246
    v_cvt_pk_bf16_f32 v77, v246, v245
    v_cvt_pk_bf16_f32 v78, v245, v245
    v_cvt_pk_bf16_f32 v79, v244, v244
    ds_write_b128 v43, v[76:79] offset:4160
    s_mov_b32 exec_lo, 0
    v_mov_b32 v255, v251
    v_mov_b32 v254, v251
    v_mov_b32 v253, v250
    v_mov_b32 v252, v249
    v_mov_b32 v251, v249
    v_mov_b32 v250, v249
    v_mov_b32 v249, v248
    v_mov_b32 v248, v247
    s_mov_b32 exec_lo, -1
    s_mov_b64 exec, 1
    v_add_f32 v247, s31, v247
    s_mov_b64 exec, -1
    v_cvt_pk_bf16_f32 v80, v254, v253
    v_cvt_pk_bf16_f32 v81, v252, v251
    v_cvt_pk_bf16_f32 v82, v250, v249
    v_cvt_pk_bf16_f32 v83, v248, v247
    ds_write_b128 v43, v[80:83] offset:1024
    v_cvt_pk_bf16_f32 v84, v255, v254
    v_cvt_pk_bf16_f32 v85, v253, v252
    v_cvt_pk_bf16_f32 v86, v251, v250
    v_cvt_pk_bf16_f32 v87, v249, v248
    ds_write_b128 v43, v[84:87] offset:5184
    v_cvt_pk_bf16_f32 v92, v247, v88
    v_mov_b32 v93, 0
    v_mov_b32 v94, 0
    v_mov_b32 v95, 0
    v_mov_b32 v96, s75
    s_mov_b64 exec, 1
    ds_write_b128 v96, v[88:91] offset:4096
    ds_write_b128 v96, v[88:91] offset:4112
    ds_write_b128 v96, v[92:95] offset:8256
    ds_write_b128 v96, v[88:91] offset:8272
    s_mov_b64 exec, -1
L_kdone:
    s_cmp_lg_u32 s61, 3
    s_cbranch_scc1 L_nouw
    s_waitcnt vmcnt(10)
L_nouw:
    s_waitcnt lgkmcnt(0)
    s_barrier
    ds_read2_b32 v[64:65], v32 offset0:176 offset1:177
    ds_read2_b32 v[66:67], v32 offset0:178 offset1:179
    ds_read_b128 v[128:131], v36 offset:192
    ds_read2_b32 v[68:69], v32 offset0:48 offset1:49
    ds_read2_b32 v[70:71], v32 offset0:50 offset1:51
    ds_read_b128 v[132:135], v36 offset:704
    ds_read2_b32 v[72:73], v33 offset0:176 offset1:177
    ds_read2_b32 v[74:75], v33 offset0:178 offset1:179
    ds_read_b128 v[136:139], v36 offset:1216
    ds_read2_b32 v[76:77], v33 offset0:48 offset1:49
    ds_read2_b32 v[78:79], v33 offset0:50 offset1:51
    ds_read_b128 v[140:143], v36 offset:1728
    ds_read2_b32 v[80:81], v34 offset0:176 offset1:177
    ds_read2_b32 v[82:83], v34 offset0:178 offset1:179
    ds_read_b128 v[144:147], v36 offset:2240
    ds_read2_b32 v[84:85], v34 offset0:48 offset1:49
    ds_read2_b32 v[86:87], v34 offset0:50 offset1:51
    ds_read_b128 v[148:151], v36 offset:2752
    ds_read2_b32 v[88:89], v35 offset0:176 offset1:177
    ds_read2_b32 v[90:91], v35 offset0:178 offset1:179
    ds_read_b128 v[152:155], v36 offset:3264
    ds_read2_b32 v[92:93], v35 offset0:48 offset1:49
    ds_read2_b32 v[94:95], v35 offset0:50 offset1:51
    ds_read_b128 v[156:159], v36 offset:3776
    s_waitcnt lgkmcnt(15)
    v_mfma_f32_16x16x32_bf16 v[192:195], v[64:67], v[128:131], 0
    v_mfma_f32_16x16x32_bf16 v[196:199], v[64:67], v[132:135], 0
    v_mfma_f32_16x16x32_bf16 v[196:199], v[68:71], v[128:131], v[196:199]
    v_mfma_f32_16x16x32_bf16 v[200:203], v[68:71], v[132:135], 0
    v_mfma_f32_16x16x32_bf16 v[200:203], v[64:67], v[136:139], v[200:203]
    s_add_u32 m0, s74, 0
    s_mov_b32 s67, 163840
    buffer_load_dwordx4 v54, s[40:43], s67 offen offset:0 lds
    s_waitcnt vmcnt(23)
    ds_read_b64_tr_b16 a[0:1], v50 offset:12288
    ds_read_b64_tr_b16 a[2:3], v50 offset:12800
    v_mfma_f32_16x16x32_bf16 v[200:203], v[72:75], v[128:131], v[200:203]
    ds_read_b64_tr_b16 a[4:5], v51 offset:12288
    ds_read_b64_tr_b16 a[6:7], v51 offset:12800
    v_mfma_f32_16x16x32_bf16 v[204:207], v[68:71], v[136:139], 0
    s_waitcnt vmcnt(21)
    ds_read_b64_tr_b16 a[8:9], v50 offset:14336
    ds_read_b64_tr_b16 a[10:11], v50 offset:14848
    v_mfma_f32_16x16x32_bf16 v[204:207], v[72:75], v[132:135], v[204:207]
    ds_read_b64_tr_b16 a[12:13], v51 offset:14336
    s_mov_b32 s67, 171008
    buffer_load_dwordx4 v54, s[40:43], s67 offen offset:1024 lds
    v_mfma_f32_16x16x32_bf16 v[208:211], v[72:75], v[136:139], 0
    ds_read_b64_tr_b16 a[14:15], v51 offset:14848
    s_waitcnt vmcnt(2)
    s_mov_b64 exec, 1
    buffer_store_dword v6, v5, s[48:51], s68 offen sc1
    s_mov_b64 exec, -1
    s_waitcnt lgkmcnt(15)
    v_mfma_f32_16x16x32_bf16 v[204:207], v[64:67], v[140:143], v[204:207]
    ds_read_b64_tr_b16 a[16:17], v50 offset:16384
    ds_read_b64_tr_b16 a[18:19], v50 offset:16896
    v_mfma_f32_16x16x32_bf16 v[204:207], v[76:79], v[128:131], v[204:207]
    ds_read_b64_tr_b16 a[20:21], v51 offset:16384
    ds_read_b64_tr_b16 a[22:23], v51 offset:16896
    v_mfma_f32_16x16x32_bf16 v[208:211], v[68:71], v[140:143], v[208:211]
    ds_read_b64_tr_b16 a[24:25], v50 offset:18432
    ds_read_b64_tr_b16 a[26:27], v50 offset:18944
    v_mfma_f32_16x16x32_bf16 v[208:211], v[76:79], v[132:135], v[208:211]
    s_add_u32 m0, s74, 2048
    s_mov_b32 s67, 180224
    buffer_load_dwordx4 v54, s[40:43], s67 offen offset:0 lds
    ds_read_b64_tr_b16 a[28:29], v51 offset:18432
    v_mfma_f32_16x16x32_bf16 v[212:215], v[72:75], v[140:143], 0
    ds_read_b64_tr_b16 a[30:31], v51 offset:18944
    ds_read2_b32 v[96:97], v32 offset0:160 offset1:161
    v_mfma_f32_16x16x32_bf16 v[212:215], v[76:79], v[136:139], v[212:215]
    ds_read2_b32 v[98:99], v32 offset0:162 offset1:163
    ds_read_b128 v[160:163], v36 offset:128
    v_mfma_f32_16x16x32_bf16 v[216:219], v[76:79], v[140:143], 0
    ds_read2_b32 v[100:101], v32 offset0:32 offset1:33
    ds_read2_b32 v[102:103], v32 offset0:34 offset1:35
    v_mfma_f32_16x16x32_bf16 v[208:211], v[64:67], v[144:147], v[208:211]
    s_mov_b32 s67, 187392
    buffer_load_dwordx4 v54, s[40:43], s67 offen offset:1024 lds
    ds_read_b128 v[164:167], v36 offset:640
    v_mfma_f32_16x16x32_bf16 v[208:211], v[80:83], v[128:131], v[208:211]
    ds_read2_b32 v[104:105], v33 offset0:160 offset1:161
    ds_read2_b32 v[106:107], v33 offset0:162 offset1:163
    v_mfma_f32_16x16x32_bf16 v[212:215], v[68:71], v[144:147], v[212:215]
    ds_read_b128 v[168:171], v36 offset:1152
    ds_read2_b32 v[108:109], v33 offset0:32 offset1:33
    v_mfma_f32_16x16x32_bf16 v[212:215], v[80:83], v[132:135], v[212:215]
    ds_read2_b32 v[110:111], v33 offset0:34 offset1:35
    ds_read_b128 v[172:175], v36 offset:1664
    v_mfma_f32_16x16x32_bf16 v[216:219], v[72:75], v[144:147], v[216:219]
    s_add_u32 m0, s74, 4096
    s_mov_b32 s67, 196608
    buffer_load_dwordx4 v54, s[40:43], s67 offen offset:0 lds
    ds_read2_b32 v[112:113], v34 offset0:160 offset1:161
    v_mfma_f32_16x16x32_bf16 v[216:219], v[80:83], v[136:139], v[216:219]
    ds_read2_b32 v[114:115], v34 offset0:162 offset1:163
    ds_read_b128 v[176:179], v36 offset:2176
    v_mfma_f32_16x16x32_bf16 v[220:223], v[76:79], v[144:147], 0
    ds_read2_b32 v[116:117], v34 offset0:32 offset1:33
    ds_read2_b32 v[118:119], v34 offset0:34 offset1:35
    v_mfma_f32_16x16x32_bf16 v[220:223], v[80:83], v[140:143], v[220:223]
    ds_read_b128 v[180:183], v36 offset:2688
    ds_read2_b32 v[120:121], v35 offset0:160 offset1:161
    s_waitcnt lgkmcnt(15)
    v_mfma_f32_16x16x32_bf16 v[212:215], v[64:67], v[148:151], v[212:215]
    s_mov_b32 s67, 203776
    buffer_load_dwordx4 v54, s[40:43], s67 offen offset:1024 lds
    ds_read2_b32 v[122:123], v35 offset0:162 offset1:163
    v_mfma_f32_16x16x32_bf16 v[212:215], v[84:87], v[128:131], v[212:215]
    ds_read_b128 v[184:187], v36 offset:3200
    ds_read2_b32 v[124:125], v35 offset0:32 offset1:33
    v_mfma_f32_16x16x32_bf16 v[216:219], v[68:71], v[148:151], v[216:219]
    ds_read2_b32 v[126:127], v35 offset0:34 offset1:35
    ds_read_b128 v[188:191], v36 offset:3712
    v_mfma_f32_16x16x32_bf16 v[216:219], v[84:87], v[132:135], v[216:219]
    ds_read_b64_tr_b16 a[32:33], v50 offset:0
    ds_read_b64_tr_b16 a[34:35], v50 offset:512
    v_mfma_f32_16x16x32_bf16 v[220:223], v[72:75], v[148:151], v[220:223]
    s_add_u32 m0, s74, 6144
    s_mov_b32 s67, 212992
    buffer_load_dwordx4 v54, s[40:43], s67 offen offset:0 lds
    ds_read_b64_tr_b16 a[36:37], v51 offset:0
    v_mfma_f32_16x16x32_bf16 v[220:223], v[84:87], v[136:139], v[220:223]
    ds_read_b64_tr_b16 a[38:39], v51 offset:512
    ds_read_b64_tr_b16 a[40:41], v50 offset:2048
    v_mfma_f32_16x16x32_bf16 v[216:219], v[64:67], v[152:155], v[216:219]
    ds_read_b64_tr_b16 a[42:43], v50 offset:2560
    ds_read_b64_tr_b16 a[44:45], v51 offset:2048
    v_mfma_f32_16x16x32_bf16 v[216:219], v[88:91], v[128:131], v[216:219]
    ds_read_b64_tr_b16 a[46:47], v51 offset:2560
    ds_read_b64_tr_b16 a[48:49], v50 offset:4096
    v_mfma_f32_16x16x32_bf16 v[220:223], v[68:71], v[152:155], v[220:223]
    s_mov_b32 s67, 220160
    buffer_load_dwordx4 v54, s[40:43], s67 offen offset:1024 lds
    ds_read_b64_tr_b16 a[50:51], v50 offset:4608
    v_mfma_f32_16x16x32_bf16 v[220:223], v[88:91], v[132:135], v[220:223]
    ds_read_b64_tr_b16 a[52:53], v51 offset:4096
    ds_read_b64_tr_b16 a[54:55], v51 offset:4608
    v_mfma_f32_16x16x32_bf16 v[220:223], v[64:67], v[156:159], v[220:223]
    ds_read_b64_tr_b16 a[56:57], v50 offset:6144
    ds_read_b64_tr_b16 a[58:59], v50 offset:6656
    v_mfma_f32_16x16x32_bf16 v[220:223], v[92:95], v[128:131], v[220:223]
    ds_read_b64_tr_b16 a[60:61], v51 offset:6144
    ds_read_b64_tr_b16 a[62:63], v51 offset:6656
    v_mfma_f32_16x16x32_bf16 v[192:195], v[96:99], v[160:163], v[192:195]
    s_add_u32 m0, s73, 12288
    s_mov_b32 s67, 229376
    buffer_load_dwordx4 v54, s[40:43], s67 offen offset:0 lds
    s_waitcnt lgkmcnt(15)
    v_mfma_f32_16x16x32_bf16 v[196:199], v[96:99], v[164:167], v[196:199]
    ds_read2_b32 v[64:65], v32 offset0:144 offset1:145
    v_mfma_f32_16x16x32_bf16 v[196:199], v[100:103], v[160:163], v[196:199]
    ds_read2_b32 v[66:67], v32 offset0:146 offset1:147
    v_mfma_f32_16x16x32_bf16 v[200:203], v[100:103], v[164:167], v[200:203]
    ds_read_b128 v[128:131], v36 offset:64
    v_mfma_f32_16x16x32_bf16 v[200:203], v[96:99], v[168:171], v[200:203]
    s_mov_b32 s67, 236544
    buffer_load_dwordx4 v54, s[40:43], s67 offen offset:1024 lds
    v_mfma_f32_16x16x32_bf16 v[200:203], v[104:107], v[160:163], v[200:203]
    ds_read2_b32 v[68:69], v32 offset0:16 offset1:17
    v_mfma_f32_16x16x32_bf16 v[204:207], v[100:103], v[168:171], v[204:207]
    ds_read2_b32 v[70:71], v32 offset0:18 offset1:19
    v_mfma_f32_16x16x32_bf16 v[204:207], v[104:107], v[164:167], v[204:207]
    s_add_u32 m0, s73, 14336
    s_mov_b32 s67, 245760
    buffer_load_dwordx4 v54, s[40:43], s67 offen offset:0 lds
    v_mfma_f32_16x16x32_bf16 v[208:211], v[104:107], v[168:171], v[208:211]
    ds_read_b128 v[132:135], v36 offset:576
    v_mfma_f32_16x16x32_bf16 v[204:207], v[96:99], v[172:175], v[204:207]
    ds_read2_b32 v[72:73], v33 offset0:144 offset1:145
    v_mfma_f32_16x16x32_bf16 v[204:207], v[108:111], v[160:163], v[204:207]
    ds_read2_b32 v[74:75], v33 offset0:146 offset1:147
    v_mfma_f32_16x16x32_bf16 v[208:211], v[100:103], v[172:175], v[208:211]
    s_mov_b32 s67, 252928
    buffer_load_dwordx4 v54, s[40:43], s67 offen offset:1024 lds
    v_mfma_f32_16x16x32_bf16 v[208:211], v[108:111], v[164:167], v[208:211]
    ds_read_b128 v[136:139], v36 offset:1088
    v_mfma_f32_16x16x32_bf16 v[212:215], v[104:107], v[172:175], v[212:215]
    ds_read2_b32 v[76:77], v33 offset0:16 offset1:17
    v_mfma_f32_16x16x32_bf16 v[212:215], v[108:111], v[168:171], v[212:215]
    s_add_u32 m0, s73, 16384
    s_mov_b32 s67, 262144
    buffer_load_dwordx4 v54, s[40:43], s67 offen offset:0 lds
    v_mfma_f32_16x16x32_bf16 v[216:219], v[108:111], v[172:175], v[216:219]
    ds_read2_b32 v[78:79], v33 offset0:18 offset1:19
    v_mfma_f32_16x16x32_bf16 v[208:211], v[96:99], v[176:179], v[208:211]
    ds_read_b128 v[140:143], v36 offset:1600
    v_mfma_f32_16x16x32_bf16 v[208:211], v[112:115], v[160:163], v[208:211]
    v_mfma_f32_16x16x32_bf16 v[212:215], v[100:103], v[176:179], v[212:215]
    s_mov_b32 s67, 269312
    buffer_load_dwordx4 v54, s[40:43], s67 offen offset:1024 lds
    v_mfma_f32_16x16x32_bf16 v[212:215], v[112:115], v[164:167], v[212:215]
    ds_read2_b32 v[80:81], v34 offset0:144 offset1:145
    v_mfma_f32_16x16x32_bf16 v[216:219], v[104:107], v[176:179], v[216:219]
    ds_read2_b32 v[82:83], v34 offset0:146 offset1:147
    v_mfma_f32_16x16x32_bf16 v[216:219], v[112:115], v[168:171], v[216:219]
    ds_read_b128 v[144:147], v36 offset:2112
    v_mfma_f32_16x16x32_bf16 v[220:223], v[108:111], v[176:179], v[220:223]
    s_add_u32 m0, s73, 18432
    s_mov_b32 s67, 278528
    buffer_load_dwordx4 v54, s[40:43], s67 offen offset:0 lds
    v_mfma_f32_16x16x32_bf16 v[220:223], v[112:115], v[172:175], v[220:223]
    ds_read2_b32 v[84:85], v34 offset0:16 offset1:17
    v_mfma_f32_16x16x32_bf16 v[212:215], v[96:99], v[180:183], v[212:215]
    ds_read2_b32 v[86:87], v34 offset0:18 offset1:19
    v_mfma_f32_16x16x32_bf16 v[212:215], v[116:119], v[160:163], v[212:215]
    s_mov_b32 s67, 285696
    buffer_load_dwordx4 v54, s[40:43], s67 offen offset:1024 lds
    v_mfma_f32_16x16x32_bf16 v[216:219], v[100:103], v[180:183], v[216:219]
    ds_read_b128 v[148:151], v36 offset:2624
    v_mfma_f32_16x16x32_bf16 v[216:219], v[116:119], v[164:167], v[216:219]
    ds_read2_b32 v[88:89], v35 offset0:144 offset1:145
    v_mfma_f32_16x16x32_bf16 v[220:223], v[104:107], v[180:183], v[220:223]
    ds_read2_b32 v[90:91], v35 offset0:146 offset1:147
    v_mfma_f32_16x16x32_bf16 v[220:223], v[116:119], v[168:171], v[220:223]
    s_waitcnt lgkmcnt(15)
    s_add_u32 m0, s73, 0
    s_mov_b32 s67, 294912
    buffer_load_dwordx4 v54, s[40:43], s67 offen offset:0 lds
    v_mfma_f32_16x16x32_bf16 v[216:219], v[96:99], v[184:187], v[216:219]
    ds_read_b128 v[152:155], v36 offset:3136
    v_mfma_f32_16x16x32_bf16 v[216:219], v[120:123], v[160:163], v[216:219]
    ds_read2_b32 v[92:93], v35 offset0:16 offset1:17
    v_mfma_f32_16x16x32_bf16 v[220:223], v[100:103], v[184:187], v[220:223]
    s_mov_b32 s67, 302080
    buffer_load_dwordx4 v54, s[40:43], s67 offen offset:1024 lds
    v_mfma_f32_16x16x32_bf16 v[220:223], v[120:123], v[164:167], v[220:223]
    ds_read2_b32 v[94:95], v35 offset0:18 offset1:19
    v_mfma_f32_16x16x32_bf16 v[220:223], v[96:99], v[188:191], v[220:223]
    ds_read_b128 v[156:159], v36 offset:3648
    v_mfma_f32_16x16x32_bf16 v[220:223], v[124:127], v[160:163], v[220:223]
    v_mfma_f32_16x16x32_bf16 v[192:195], v[64:67], v[128:131], v[192:195]
    s_add_u32 m0, s73, 2048
    s_mov_b32 s67, 311296
    buffer_load_dwordx4 v54, s[40:43], s67 offen offset:0 lds
    s_waitcnt lgkmcnt(15)
    v_mfma_f32_16x16x32_bf16 v[196:199], v[64:67], v[132:135], v[196:199]
    ds_read2_b32 v[96:97], v32 offset0:128 offset1:129
    v_mfma_f32_16x16x32_bf16 v[196:199], v[68:71], v[128:131], v[196:199]
    ds_read2_b32 v[98:99], v32 offset0:130 offset1:131
    v_mfma_f32_16x16x32_bf16 v[200:203], v[68:71], v[132:135], v[200:203]
    ds_read_b128 v[160:163], v36 offset:0
    v_mfma_f32_16x16x32_bf16 v[200:203], v[64:67], v[136:139], v[200:203]
    s_mov_b32 s67, 318464
    buffer_load_dwordx4 v54, s[40:43], s67 offen offset:1024 lds
    v_mfma_f32_16x16x32_bf16 v[200:203], v[72:75], v[128:131], v[200:203]
    ds_read2_b32 v[100:101], v32 offset0:0 offset1:1
    v_mfma_f32_16x16x32_bf16 v[204:207], v[68:71], v[136:139], v[204:207]
    ds_read2_b32 v[102:103], v32 offset0:2 offset1:3
    v_mfma_f32_16x16x32_bf16 v[204:207], v[72:75], v[132:135], v[204:207]
    v_mfma_f32_16x16x32_bf16 v[208:211], v[72:75], v[136:139], v[208:211]
    ds_read_b128 v[164:167], v36 offset:512
    s_waitcnt lgkmcnt(15)
    v_mfma_f32_16x16x32_bf16 v[204:207], v[64:67], v[140:143], v[204:207]
    s_add_u32 m0, s73, 4096
    s_mov_b32 s67, 327680
    buffer_load_dwordx4 v54, s[40:43], s67 offen offset:0 lds
    v_mfma_f32_16x16x32_bf16 v[204:207], v[76:79], v[128:131], v[204:207]
    ds_read2_b32 v[104:105], v33 offset0:128 offset1:129
    v_mfma_f32_16x16x32_bf16 v[208:211], v[68:71], v[140:143], v[208:211]
    ds_read2_b32 v[106:107], v33 offset0:130 offset1:131
    v_mfma_f32_16x16x32_bf16 v[208:211], v[76:79], v[132:135], v[208:211]
    s_mov_b32 s67, 334848
    buffer_load_dwordx4 v54, s[40:43], s67 offen offset:1024 lds
    v_mfma_f32_16x16x32_bf16 v[212:215], v[72:75], v[140:143], v[212:215]
    ds_read_b128 v[168:171], v36 offset:1024
    v_mfma_f32_16x16x32_bf16 v[212:215], v[76:79], v[136:139], v[212:215]
    v_mfma_f32_16x16x32_bf16 v[216:219], v[76:79], v[140:143], v[216:219]
    ds_read2_b32 v[108:109], v33 offset0:0 offset1:1
    v_mfma_f32_16x16x32_bf16 v[208:211], v[64:67], v[144:147], v[208:211]
    ds_read2_b32 v[110:111], v33 offset0:2 offset1:3
    v_mfma_f32_16x16x32_bf16 v[208:211], v[80:83], v[128:131], v[208:211]
    s_add_u32 m0, s73, 6144
    s_mov_b32 s67, 344064
    buffer_load_dwordx4 v54, s[40:43], s67 offen offset:0 lds
    v_mfma_f32_16x16x32_bf16 v[212:215], v[68:71], v[144:147], v[212:215]
    ds_read_b128 v[172:175], v36 offset:1536
    v_mfma_f32_16x16x32_bf16 v[212:215], v[80:83], v[132:135], v[212:215]
    ds_read2_b32 v[112:113], v34 offset0:128 offset1:129
    v_mfma_f32_16x16x32_bf16 v[216:219], v[72:75], v[144:147], v[216:219]
    ds_read2_b32 v[114:115], v34 offset0:130 offset1:131
    v_mfma_f32_16x16x32_bf16 v[216:219], v[80:83], v[136:139], v[216:219]
    v_mfma_f32_16x16x32_bf16 v[220:223], v[76:79], v[144:147], v[220:223]
    s_mov_b32 s67, 351232
    buffer_load_dwordx4 v54, s[40:43], s67 offen offset:1024 lds
    v_mfma_f32_16x16x32_bf16 v[220:223], v[80:83], v[140:143], v[220:223]
    ds_read_b128 v[176:179], v36 offset:2048
    s_waitcnt lgkmcnt(15)
    v_mfma_f32_16x16x32_bf16 v[212:215], v[64:67], v[148:151], v[212:215]
    ds_read2_b32 v[116:117], v34 offset0:0 offset1:1
    v_mfma_f32_16x16x32_bf16 v[212:215], v[84:87], v[128:131], v[212:215]
    buffer_load_dword v62, v31, s[48:51], s99 offen sc1
    v_mfma_f32_16x16x32_bf16 v[216:219], v[68:71], v[148:151], v[216:219]
    ds_read2_b32 v[118:119], v34 offset0:2 offset1:3
    v_mfma_f32_16x16x32_bf16 v[216:219], v[84:87], v[132:135], v[216:219]
    ds_read_b128 v[180:183], v36 offset:2560
    v_mfma_f32_16x16x32_bf16 v[220:223], v[72:75], v[148:151], v[220:223]
    v_mfma_f32_16x16x32_bf16 v[220:223], v[84:87], v[136:139], v[220:223]
    ds_read2_b32 v[120:121], v35 offset0:128 offset1:129
    v_mfma_f32_16x16x32_bf16 v[216:219], v[64:67], v[152:155], v[216:219]
    ds_read2_b32 v[122:123], v35 offset0:130 offset1:131
    v_mfma_f32_16x16x32_bf16 v[216:219], v[88:91], v[128:131], v[216:219]
    ds_read_b128 v[184:187], v36 offset:3072
    v_mfma_f32_16x16x32_bf16 v[220:223], v[68:71], v[152:155], v[220:223]
    ds_read2_b32 v[124:125], v35 offset0:0 offset1:1
    v_mfma_f32_16x16x32_bf16 v[220:223], v[88:91], v[132:135], v[220:223]
    ds_read2_b32 v[126:127], v35 offset0:2 offset1:3
    v_mfma_f32_16x16x32_bf16 v[220:223], v[64:67], v[156:159], v[220:223]
    ds_read_b128 v[188:191], v36 offset:3584
    v_mfma_f32_16x16x32_bf16 v[220:223], v[92:95], v[128:131], v[220:223]
    s_waitcnt lgkmcnt(15)
    v_mfma_f32_16x16x32_bf16 v[192:195], v[96:99], v[160:163], v[192:195]
    v_mfma_f32_16x16x32_bf16 v[196:199], v[96:99], v[164:167], v[196:199]
    s_waitcnt vmcnt(0)
    s_mov_b64 exec, 0xff
    v_cmp_ne_u32 vcc, s62, v62
    s_mov_b64 exec, -1
    s_cbranch_vccz L_fhok
    s_mov_b32 s3, 0x40000
    s_branch Lp0h_7
Lpollh_5:
    s_sleep 2
Lp0h_7:
    s_load_dwordx8 s[4:11], s[28:29], s99 glc
    s_waitcnt lgkmcnt(0)
    s_xor_b64 s[4:5], s[4:5], s[62:63]
    s_xor_b64 s[6:7], s[6:7], s[62:63]
    s_xor_b64 s[8:9], s[8:9], s[62:63]
    s_xor_b64 s[10:11], s[10:11], s[62:63]
    s_or_b64 s[4:5], s[4:5], s[6:7]
    s_or_b64 s[4:5], s[4:5], s[8:9]
    s_or_b64 s[4:5], s[4:5], s[10:11]
    s_cbranch_scc0 Lpdh_6
    s_sub_u32 s3, s3, 1
    s_cbranch_scc0 Lpollh_5
Lpdh_6:
L_fhok:
    v_mfma_f32_16x16x32_bf16 v[196:199], v[100:103], v[160:163], v[196:199]
    buffer_load_dwordx4 a[224:227], v52, s[52:55], s77 offen offset:0 sc1
    v_mfma_f32_16x16x32_bf16 v[200:203], v[100:103], v[164:167], v[200:203]
    v_mfma_f32_16x16x32_bf16 v[200:203], v[96:99], v[168:171], v[200:203]
    buffer_load_dwordx4 a[228:231], v53, s[52:55], s77 offen offset:0 sc1
    v_mfma_f32_16x16x32_bf16 v[200:203], v[104:107], v[160:163], v[200:203]
    v_mfma_f32_16x16x32_bf16 v[204:207], v[100:103], v[168:171], v[204:207]
    v_mfma_f32_16x16x32_bf16 v[204:207], v[104:107], v[164:167], v[204:207]
    buffer_load_dwordx4 a[232:235], v52, s[52:55], s77 offen offset:2048 sc1
    v_mfma_f32_16x16x32_bf16 v[208:211], v[104:107], v[168:171], v[208:211]
    s_waitcnt lgkmcnt(12)
    v_mfma_f32_16x16x32_bf16 v[204:207], v[96:99], v[172:175], v[204:207]
    v_mfma_f32_16x16x32_bf16 v[204:207], v[108:111], v[160:163], v[204:207]
    buffer_load_dwordx4 a[236:239], v53, s[52:55], s77 offen offset:2048 sc1
    v_mfma_f32_16x16x32_bf16 v[208:211], v[100:103], v[172:175], v[208:211]
    v_mfma_f32_16x16x32_bf16 v[208:211], v[108:111], v[164:167], v[208:211]
    v_mfma_f32_16x16x32_bf16 v[212:215], v[104:107], v[172:175], v[212:215]
    s_add_u32 s77, s77, 4096
    buffer_load_dwordx4 a[240:243], v52, s[52:55], s77 offen offset:0 sc1
    v_mfma_f32_16x16x32_bf16 v[212:215], v[108:111], v[168:171], v[212:215]
    v_mfma_f32_16x16x32_bf16 v[216:219], v[108:111], v[172:175], v[216:219]
    s_waitcnt lgkmcnt(9)
    v_mfma_f32_16x16x32_bf16 v[208:211], v[96:99], v[176:179], v[208:211]
    buffer_load_dwordx4 a[244:247], v53, s[52:55], s77 offen offset:0 sc1
    v_mfma_f32_16x16x32_bf16 v[208:211], v[112:115], v[160:163], v[208:211]
    v_mfma_f32_16x16x32_bf16 v[212:215], v[100:103], v[176:179], v[212:215]
    v_mfma_f32_16x16x32_bf16 v[212:215], v[112:115], v[164:167], v[212:215]
    buffer_load_dwordx4 a[248:251], v52, s[52:55], s77 offen offset:2048 sc1
    v_mfma_f32_16x16x32_bf16 v[216:219], v[104:107], v[176:179], v[216:219]
    v_mfma_f32_16x16x32_bf16 v[216:219], v[112:115], v[168:171], v[216:219]
    buffer_load_dwordx4 a[252:255], v53, s[52:55], s77 offen offset:2048 sc1
    v_mfma_f32_16x16x32_bf16 v[220:223], v[108:111], v[176:179], v[220:223]
    v_mfma_f32_16x16x32_bf16 v[220:223], v[112:115], v[172:175], v[220:223]
    s_waitcnt lgkmcnt(6)
    v_mfma_f32_16x16x32_bf16 v[212:215], v[96:99], v[180:183], v[212:215]
    s_add_u32 s77, s77, 4096
    buffer_load_dwordx4 a[128:131], v52, s[52:55], s77 offen offset:0 sc1
    v_mfma_f32_16x16x32_bf16 v[212:215], v[116:119], v[160:163], v[212:215]
    v_mfma_f32_16x16x32_bf16 v[216:219], v[100:103], v[180:183], v[216:219]
    v_mfma_f32_16x16x32_bf16 v[216:219], v[116:119], v[164:167], v[216:219]
    buffer_load_dwordx4 a[132:135], v53, s[52:55], s77 offen offset:0 sc1
    v_mfma_f32_16x16x32_bf16 v[220:223], v[104:107], v[180:183], v[220:223]
    v_mfma_f32_16x16x32_bf16 v[220:223], v[116:119], v[168:171], v[220:223]
    s_waitcnt lgkmcnt(3)
    v_mfma_f32_16x16x32_bf16 v[216:219], v[96:99], v[184:187], v[216:219]
    buffer_load_dwordx4 a[136:139], v52, s[52:55], s77 offen offset:2048 sc1
    v_mfma_f32_16x16x32_bf16 v[216:219], v[120:123], v[160:163], v[216:219]
    v_mfma_f32_16x16x32_bf16 v[220:223], v[100:103], v[184:187], v[220:223]
    v_mfma_f32_16x16x32_bf16 v[220:223], v[120:123], v[164:167], v[220:223]
    buffer_load_dwordx4 a[140:143], v53, s[52:55], s77 offen offset:2048 sc1
    s_waitcnt lgkmcnt(0)
    v_mfma_f32_16x16x32_bf16 v[220:223], v[96:99], v[188:191], v[220:223]
    v_mfma_f32_16x16x32_bf16 v[220:223], v[124:127], v[160:163], v[220:223]
    s_bitcmp1_b32 s61, 0
    s_cbranch_scc1 L_codd
    s_nop 4
    ds_write_b128 v37, v[208:211] offset:0
    ds_write_b128 v37, v[212:215] offset:1024
    ds_write_b128 v37, v[216:219] offset:2048
    ds_write_b128 v37, v[220:223] offset:3072
    s_branch L_cjoin
L_codd:
    s_nop 7
    ds_write_b128 v37, v[192:195] offset:0
    ds_write_b128 v37, v[196:199] offset:1024
    ds_write_b128 v37, v[200:203] offset:2048
    ds_write_b128 v37, v[204:207] offset:3072
    s_nop 1
    v_pk_mul_f32 v[192:193], v[208:209], 1.0 op_sel_hi:[1,0]
    v_pk_mul_f32 v[194:195], v[210:211], 1.0 op_sel_hi:[1,0]
    v_pk_mul_f32 v[196:197], v[212:213], 1.0 op_sel_hi:[1,0]
    v_pk_mul_f32 v[198:199], v[214:215], 1.0 op_sel_hi:[1,0]
    v_pk_mul_f32 v[200:201], v[216:217], 1.0 op_sel_hi:[1,0]
    v_pk_mul_f32 v[202:203], v[218:219], 1.0 op_sel_hi:[1,0]
    v_pk_mul_f32 v[204:205], v[220:221], 1.0 op_sel_hi:[1,0]
    v_pk_mul_f32 v[206:207], v[222:223], 1.0 op_sel_hi:[1,0]
L_cjoin:
    s_waitcnt vmcnt(10)
    v_mfma_f32_32x32x16_bf16 v[240:255], a[0:3], a[224:227], 0
    s_add_u32 s77, s77, 4096
    buffer_load_dwordx4 a[144:147], v52, s[52:55], s77 offen offset:0 sc1
    buffer_load_dwordx4 a[148:151], v53, s[52:55], s77 offen offset:0 sc1
    v_mfma_f32_32x32x16_bf16 a[176:191], a[0:3], a[228:231], 0
    ds_read_b64_tr_b16 a[64:65], v50 offset:8192
    v_mfma_f32_32x32x16_bf16 a[192:207], a[4:7], a[224:227], 0
    ds_read_b64_tr_b16 a[66:67], v50 offset:8704
    ds_read_b64_tr_b16 a[68:69], v51 offset:8192
    v_mfma_f32_32x32x16_bf16 a[208:223], a[4:7], a[228:231], 0
    ds_read_b64_tr_b16 a[70:71], v51 offset:8704
    s_waitcnt lgkmcnt(0)
    s_barrier
    s_waitcnt vmcnt(10)
    v_mfma_f32_32x32x16_bf16 v[240:255], a[8:11], a[232:235], v[240:255]
    ds_read_b128 v[224:227], v38 offset:0
    ds_read_b128 v[228:231], v38 offset:1024
    ds_read_b128 v[232:235], v38 offset:2048
    v_mfma_f32_32x32x16_bf16 a[176:191], a[8:11], a[236:239], a[176:191]
    ds_read_b128 v[236:239], v38 offset:3072
    s_or_b32 s64, s2, s61
    s_cmp_lg_u32 s64, 0
    s_cselect_b32 s64, 1073741824, 10551296
    v_mov_b32 v63, s79
    s_mov_b64 exec, 1
    buffer_store_dword v63, v5, s[48:51], s64 offen sc1
    s_mov_b64 exec, -1
    buffer_load_dwordx4 a[152:155], v52, s[52:55], s77 offen offset:2048 sc1
    v_mfma_f32_32x32x16_bf16 a[192:207], a[12:15], a[232:235], a[192:207]
    buffer_load_dwordx4 a[156:159], v53, s[52:55], s77 offen offset:2048 sc1
    ds_read_b64_tr_b16 a[72:73], v50 offset:10240
    ds_read_b64_tr_b16 a[74:75], v50 offset:10752
    v_mfma_f32_32x32x16_bf16 a[208:223], a[12:15], a[236:239], a[208:223]
    ds_read_b64_tr_b16 a[76:77], v51 offset:10240
    ds_read_b64_tr_b16 a[78:79], v51 offset:10752
    s_waitcnt vmcnt(11)
    v_mfma_f32_32x32x16_bf16 v[240:255], a[16:19], a[240:243], v[240:255]
    s_waitcnt lgkmcnt(7)
    s_add_u32 s77, s77, 4096
    buffer_load_dwordx4 a[160:163], v52, s[52:55], s77 offen offset:0 sc1
    v_add_f32 v192, v192, v224
    v_add_f32 v193, v193, v225
    buffer_load_dwordx4 a[164:167], v53, s[52:55], s77 offen offset:0 sc1
    v_add_f32 v194, v194, v226
    v_mfma_f32_32x32x16_bf16 a[176:191], a[16:19], a[244:247], a[176:191]
    v_add_f32 v195, v195, v227
    v_cvt_pk_bf16_f32 v208, v192, v193
    ds_read_b64_tr_b16 a[80:81], v40 offset:0
    v_cvt_pk_bf16_f32 v209, v194, v195
    s_waitcnt lgkmcnt(7)
    v_add_f32 v196, v196, v228
    v_mfma_f32_32x32x16_bf16 a[192:207], a[20:23], a[240:243], a[192:207]
    ds_read_b64_tr_b16 a[82:83], v40 offset:512
    v_add_f32 v197, v197, v229
    v_add_f32 v198, v198, v230
    v_add_f32 v199, v199, v231
    ds_read_b64_tr_b16 a[84:85], v41 offset:0
    v_cvt_pk_bf16_f32 v210, v196, v197
    v_mfma_f32_32x32x16_bf16 a[208:223], a[20:23], a[244:247], a[208:223]
    v_cvt_pk_bf16_f32 v211, v198, v199
    v_permlane16_swap_b32 v208, v210
    ds_read_b64_tr_b16 a[86:87], v41 offset:512
    v_permlane16_swap_b32 v209, v211
    buffer_store_dwordx4 v[208:211], v39, s[48:51], s76 offen offset:0 sc1
    s_waitcnt vmcnt(12)
    v_mfma_f32_32x32x16_bf16 v[240:255], a[24:27], a[248:251], v[240:255]
    s_waitcnt lgkmcnt(9)
    buffer_load_dwordx4 a[168:171], v52, s[52:55], s77 offen offset:2048 sc1
    v_add_f32 v200, v200, v232
    v_add_f32 v201, v201, v233
    buffer_load_dwordx4 a[172:175], v53, s[52:55], s77 offen offset:2048 sc1
    v_add_f32 v202, v202, v234
    v_mfma_f32_32x32x16_bf16 a[176:191], a[24:27], a[252:255], a[176:191]
    v_add_f32 v203, v203, v235
    v_cvt_pk_bf16_f32 v212, v200, v201
    ds_read_b64_tr_b16 a[88:89], v40 offset:2048
    v_cvt_pk_bf16_f32 v213, v202, v203
    s_waitcnt lgkmcnt(9)
    v_add_f32 v204, v204, v236
    v_mfma_f32_32x32x16_bf16 a[192:207], a[28:31], a[248:251], a[192:207]
    ds_read_b64_tr_b16 a[90:91], v40 offset:2560
    v_add_f32 v205, v205, v237
    v_add_f32 v206, v206, v238
    v_add_f32 v207, v207, v239
    ds_read_b64_tr_b16 a[92:93], v41 offset:2048
    v_cvt_pk_bf16_f32 v214, v204, v205
    v_mfma_f32_32x32x16_bf16 a[208:223], a[28:31], a[252:255], a[208:223]
    v_cvt_pk_bf16_f32 v215, v206, v207
    v_permlane16_swap_b32 v212, v214
    ds_read_b64_tr_b16 a[94:95], v41 offset:2560
    v_permlane16_swap_b32 v213, v215
    buffer_store_dwordx4 v[212:215], v39, s[48:51], s76 offen offset:1024 sc1
    s_waitcnt vmcnt(13)
    v_mfma_f32_32x32x16_bf16 v[240:255], a[32:35], a[128:131], v[240:255]
    s_add_u32 s77, s77, 4096
    buffer_load_dwordx4 v[64:67], v52, s[52:55], s77 offen offset:0 sc1
    buffer_load_dwordx4 v[68:71], v53, s[52:55], s77 offen offset:0 sc1
    v_mfma_f32_32x32x16_bf16 a[176:191], a[32:35], a[132:135], a[176:191]
    ds_read_b64_tr_b16 a[96:97], v40 offset:4096
    v_mfma_f32_32x32x16_bf16 a[192:207], a[36:39], a[128:131], a[192:207]
    ds_read_b64_tr_b16 a[98:99], v40 offset:4608
    ds_read_b64_tr_b16 a[100:101], v41 offset:4096
    v_mfma_f32_32x32x16_bf16 a[208:223], a[36:39], a[132:135], a[208:223]
    ds_read_b64_tr_b16 a[102:103], v41 offset:4608
    s_waitcnt vmcnt(13)
    v_mfma_f32_32x32x16_bf16 v[240:255], a[40:43], a[136:139], v[240:255]
    buffer_load_dwordx4 v[72:75], v52, s[52:55], s77 offen offset:2048 sc1
    buffer_load_dwordx4 v[76:79], v53, s[52:55], s77 offen offset:2048 sc1
    v_mfma_f32_32x32x16_bf16 a[176:191], a[40:43], a[140:143], a[176:191]
    ds_read_b64_tr_b16 a[104:105], v40 offset:6144
    v_mfma_f32_32x32x16_bf16 a[192:207], a[44:47], a[136:139], a[192:207]
    ds_read_b64_tr_b16 a[106:107], v40 offset:6656
    ds_read_b64_tr_b16 a[108:109], v41 offset:6144
    v_mfma_f32_32x32x16_bf16 a[208:223], a[44:47], a[140:143], a[208:223]
    ds_read_b64_tr_b16 a[110:111], v41 offset:6656
    s_waitcnt vmcnt(13)
    v_mfma_f32_32x32x16_bf16 v[240:255], a[48:51], a[144:147], v[240:255]
    s_add_u32 s77, s77, 4096
    buffer_load_dwordx4 v[80:83], v52, s[52:55], s77 offen offset:0 sc1
    buffer_load_dwordx4 v[84:87], v53, s[52:55], s77 offen offset:0 sc1
    v_mfma_f32_32x32x16_bf16 a[176:191], a[48:51], a[148:151], a[176:191]
    ds_read_b64_tr_b16 a[112:113], v50 offset:12288
    v_mfma_f32_32x32x16_bf16 a[192:207], a[52:55], a[144:147], a[192:207]
    ds_read_b64_tr_b16 a[114:115], v50 offset:12800
    ds_read_b64_tr_b16 a[116:117], v51 offset:12288
    v_mfma_f32_32x32x16_bf16 a[208:223], a[52:55], a[148:151], a[208:223]
    ds_read_b64_tr_b16 a[118:119], v51 offset:12800
    s_waitcnt vmcnt(12)
    v_mfma_f32_32x32x16_bf16 v[240:255], a[56:59], a[152:155], v[240:255]
    buffer_load_dwordx4 v[88:91], v52, s[52:55], s77 offen offset:2048 sc1
    buffer_load_dwordx4 v[92:95], v53, s[52:55], s77 offen offset:2048 sc1
    v_mfma_f32_32x32x16_bf16 a[176:191], a[56:59], a[156:159], a[176:191]
    ds_read_b64_tr_b16 a[120:121], v50 offset:14336
    v_mfma_f32_32x32x16_bf16 a[192:207], a[60:63], a[152:155], a[192:207]
    ds_read_b64_tr_b16 a[122:123], v50 offset:14848
    ds_read_b64_tr_b16 a[124:125], v51 offset:14336
    v_mfma_f32_32x32x16_bf16 a[208:223], a[60:63], a[156:159], a[208:223]
    ds_read_b64_tr_b16 a[126:127], v51 offset:14848
    s_waitcnt vmcnt(12)
    v_mfma_f32_32x32x16_bf16 v[240:255], a[64:67], a[160:163], v[240:255]
    s_add_u32 s77, s77, 4096
    buffer_load_dwordx4 v[128:131], v52, s[52:55], s77 offen offset:0 sc1
    buffer_load_dwordx4 v[132:135], v53, s[52:55], s77 offen offset:0 sc1
    v_mfma_f32_32x32x16_bf16 a[176:191], a[64:67], a[164:167], a[176:191]
    ds_read_b64_tr_b16 a[128:129], v50 offset:16384
    v_mfma_f32_32x32x16_bf16 a[192:207], a[68:71], a[160:163], a[192:207]
    ds_read_b64_tr_b16 a[130:131], v50 offset:16896
    ds_read_b64_tr_b16 a[132:133], v51 offset:16384
    v_mfma_f32_32x32x16_bf16 a[208:223], a[68:71], a[164:167], a[208:223]
    ds_read_b64_tr_b16 a[134:135], v51 offset:16896
    s_waitcnt vmcnt(11)
    s_waitcnt lgkmcnt(15)
    v_mfma_f32_32x32x16_bf16 v[240:255], a[72:75], a[168:171], v[240:255]
    buffer_load_dwordx4 v[136:139], v52, s[52:55], s77 offen offset:2048 sc1
    buffer_load_dwordx4 v[140:143], v53, s[52:55], s77 offen offset:2048 sc1
    v_mfma_f32_32x32x16_bf16 a[176:191], a[72:75], a[172:175], a[176:191]
    ds_read_b64_tr_b16 a[136:137], v50 offset:18432
    v_mfma_f32_32x32x16_bf16 a[192:207], a[76:79], a[168:171], a[192:207]
    ds_read_b64_tr_b16 a[138:139], v50 offset:18944
    ds_read_b64_tr_b16 a[140:141], v51 offset:18432
    v_mfma_f32_32x32x16_bf16 a[208:223], a[76:79], a[172:175], a[208:223]
    ds_read_b64_tr_b16 a[142:143], v51 offset:18944
    s_waitcnt vmcnt(10)
    v_mfma_f32_32x32x16_bf16 v[240:255], a[80:83], v[64:67], v[240:255]
    s_add_u32 s77, s77, 4096
    buffer_load_dwordx4 v[144:147], v52, s[52:55], s77 offen offset:0 sc1
    v_permlane32_swap_b32 v8, v10
    v_permlane32_swap_b32 v9, v11
    buffer_load_dwordx4 v[148:151], v53, s[52:55], s77 offen offset:0 sc1
    v_mfma_f32_32x32x16_bf16 a[176:191], a[80:83], v[68:71], a[176:191]
    v_permlane32_swap_b32 v12, v14
    v_permlane32_swap_b32 v13, v15
    ds_read_b64_tr_b16 a[144:145], v50 offset:0
    v_lshlrev_b32 v200, 16, v8
    v_mfma_f32_32x32x16_bf16 a[192:207], a[84:87], v[64:67], a[192:207]
    v_and_b32 v201, 0xffff0000, v8
    ds_read_b64_tr_b16 a[146:147], v50 offset:512
    v_lshlrev_b32 v202, 16, v9
    v_and_b32 v203, 0xffff0000, v9
    ds_read_b64_tr_b16 a[148:149], v51 offset:0
    v_mfma_f32_32x32x16_bf16 a[208:223], a[84:87], v[68:71], a[208:223]
    v_lshlrev_b32 v204, 16, v10
    v_and_b32 v205, 0xffff0000, v10
    ds_read_b64_tr_b16 a[150:151], v51 offset:512
    v_lshlrev_b32 v206, 16, v11
    s_waitcnt vmcnt(10)
    v_mfma_f32_32x32x16_bf16 v[240:255], a[88:91], v[72:75], v[240:255]
    v_and_b32 v207, 0xffff0000, v11
    buffer_load_dwordx4 v[152:155], v52, s[52:55], s77 offen offset:2048 sc1
    v_lshlrev_b32 v208, 16, v12
    buffer_load_dwordx4 v[156:159], v53, s[52:55], s77 offen offset:2048 sc1
    v_and_b32 v209, 0xffff0000, v12
    v_mfma_f32_32x32x16_bf16 a[176:191], a[88:91], v[76:79], a[176:191]
    v_lshlrev_b32 v210, 16, v13
    ds_read_b64_tr_b16 a[152:153], v50 offset:2048
    v_and_b32 v211, 0xffff0000, v13
    v_lshlrev_b32 v212, 16, v14
    v_mfma_f32_32x32x16_bf16 a[192:207], a[92:95], v[72:75], a[192:207]
    ds_read_b64_tr_b16 a[154:155], v50 offset:2560
    v_and_b32 v213, 0xffff0000, v14
    v_lshlrev_b32 v214, 16, v15
    ds_read_b64_tr_b16 a[156:157], v51 offset:2048
    v_mfma_f32_32x32x16_bf16 a[208:223], a[92:95], v[76:79], a[208:223]
    v_and_b32 v215, 0xffff0000, v15
    v_mov_b32 v56, s81
    ds_read_b64_tr_b16 a[158:159], v51 offset:2560
    v_mov_b32 v57, s81
    s_waitcnt vmcnt(10)
    v_mfma_f32_32x32x16_bf16 v[240:255], a[96:99], v[80:83], v[240:255]
    s_add_u32 s77, s77, 4096
    buffer_load_dwordx4 v[96:99], v52, s[52:55], s77 offen offset:0 sc1
    buffer_load_dwordx4 v[100:103], v53, s[52:55], s77 offen offset:0 sc1
    v_mfma_f32_32x32x16_bf16 a[176:191], a[96:99], v[84:87], a[176:191]
    ds_read_b64_tr_b16 a[160:161], v50 offset:4096
    v_mfma_f32_32x32x16_bf16 a[192:207], a[100:103], v[80:83], a[192:207]
    ds_read_b64_tr_b16 a[162:163], v50 offset:4608
    ds_read_b64_tr_b16 a[164:165], v51 offset:4096
    v_mfma_f32_32x32x16_bf16 a[208:223], a[100:103], v[84:87], a[208:223]
    ds_read_b64_tr_b16 a[166:167], v51 offset:4608
    buffer_load_dwordx4 v[192:195], v19, s[48:51], s78 offen sc1
    buffer_load_dwordx4 v[196:199], v19, s[48:51], s93 offen sc1
    s_waitcnt vmcnt(12)
    s_waitcnt lgkmcnt(15)
    v_mfma_f32_32x32x16_bf16 v[240:255], a[104:107], v[88:91], v[240:255]
    buffer_load_dwordx4 v[104:107], v52, s[52:55], s77 offen offset:2048 sc1
    buffer_load_dwordx4 v[108:111], v53, s[52:55], s77 offen offset:2048 sc1
    v_mfma_f32_32x32x16_bf16 a[176:191], a[104:107], v[92:95], a[176:191]
    ds_read_b64_tr_b16 a[168:169], v50 offset:6144
    v_mfma_f32_32x32x16_bf16 a[192:207], a[108:111], v[88:91], a[192:207]
    ds_read_b64_tr_b16 a[170:171], v50 offset:6656
    ds_read_b64_tr_b16 a[172:173], v51 offset:6144
    v_mfma_f32_32x32x16_bf16 a[208:223], a[108:111], v[92:95], a[208:223]
    ds_read_b64_tr_b16 a[174:175], v51 offset:6656
    s_waitcnt vmcnt(12)
    v_mfma_f32_32x32x16_bf16 v[240:255], a[112:115], v[128:131], v[240:255]
    s_add_u32 s77, s77, 4096
    buffer_load_dwordx4 v[112:115], v52, s[52:55], s77 offen offset:0 sc1
    v_mfma_f32_32x32x16_bf16 a[176:191], a[112:115], v[132:135], a[176:191]
    v_mfma_f32_32x32x16_bf16 a[192:207], a[116:119], v[128:131], a[192:207]
    buffer_load_dwordx4 v[116:119], v53, s[52:55], s77 offen offset:0 sc1
    v_mfma_f32_32x32x16_bf16 a[208:223], a[116:119], v[132:135], a[208:223]
    s_waitcnt vmcnt(12)
    v_mfma_f32_32x32x16_bf16 v[240:255], a[120:123], v[136:139], v[240:255]
    buffer_load_dwordx4 v[120:123], v52, s[52:55], s77 offen offset:2048 sc1
    v_mfma_f32_32x32x16_bf16 a[176:191], a[120:123], v[140:143], a[176:191]
    v_mfma_f32_32x32x16_bf16 a[192:207], a[124:127], v[136:139], a[192:207]
    buffer_load_dwordx4 v[124:127], v53, s[52:55], s77 offen offset:2048 sc1
    v_mfma_f32_32x32x16_bf16 a[208:223], a[124:127], v[140:143], a[208:223]
    s_waitcnt vmcnt(12)
    v_mfma_f32_32x32x16_bf16 v[240:255], a[128:131], v[144:147], v[240:255]
    v_mfma_f32_32x32x16_bf16 a[176:191], a[128:131], v[148:151], a[176:191]
    v_mfma_f32_32x32x16_bf16 a[192:207], a[132:135], v[144:147], a[192:207]
    v_mfma_f32_32x32x16_bf16 a[208:223], a[132:135], v[148:151], a[208:223]
    s_waitcnt vmcnt(10)
    s_waitcnt lgkmcnt(15)
    v_mfma_f32_32x32x16_bf16 v[240:255], a[136:139], v[152:155], v[240:255]
    v_mfma_f32_32x32x16_bf16 a[176:191], a[136:139], v[156:159], a[176:191]
    v_mfma_f32_32x32x16_bf16 a[192:207], a[140:143], v[152:155], a[192:207]
    v_mfma_f32_32x32x16_bf16 a[208:223], a[140:143], v[156:159], a[208:223]
    s_waitcnt vmcnt(8)
    s_waitcnt lgkmcnt(12)
    v_mfma_f32_32x32x16_bf16 v[240:255], a[144:147], v[96:99], v[240:255]
    v_mfma_f32_32x32x16_bf16 a[176:191], a[144:147], v[100:103], a[176:191]
    v_mfma_f32_32x32x16_bf16 a[192:207], a[148:151], v[96:99], a[192:207]
    v_mfma_f32_32x32x16_bf16 a[208:223], a[148:151], v[100:103], a[208:223]
    s_mov_b32 s3, 0x40000
    s_branch L_sck
L_srl:
    s_sleep 1
    buffer_load_dwordx4 v[192:195], v19, s[48:51], s78 offen sc1
    buffer_load_dwordx4 v[196:199], v19, s[48:51], s93 offen sc1
L_sck:
    s_waitcnt vmcnt(0)
    v_max3_u32 v58, v192, v193, v194
    v_max3_u32 v59, v195, v196, v197
    v_max3_u32 v58, v58, v198, v199
    v_max_u32 v58, v58, v59
    v_cmp_eq_u32 vcc, -1, v58
    s_cbranch_vccz L_sok
    s_sub_u32 s3, s3, 1
    s_cbranch_scc0 L_srl
L_sok:
    s_waitcnt lgkmcnt(0)
    v_mfma_f32_32x32x16_bf16 a[176:191], a[152:155], v[108:111], a[176:191]
    ds_write_b128 v4, v[192:195] offset:12288
    v_mfma_f32_32x32x16_bf16 a[176:191], a[160:163], v[116:119], a[176:191]
    ds_write_b128 v4, v[196:199] offset:13312
    v_mfma_f32_32x32x16_bf16 a[176:191], a[168:171], v[124:127], a[176:191]
    v_mfma_f32_32x32x16_bf16 a[192:207], a[156:159], v[104:107], a[192:207]
    v_mfma_f32_32x32x16_bf16 a[192:207], a[164:167], v[112:115], a[192:207]
    v_mfma_f32_32x32x16_bf16 a[192:207], a[172:175], v[120:123], a[192:207]
    v_mfma_f32_32x32x16_bf16 a[208:223], a[156:159], v[108:111], a[208:223]
    s_nop 7
    ds_write_b128 v4, a[176:179] offset:0
    ds_write_b128 v4, a[180:183] offset:1024
    v_mfma_f32_32x32x16_bf16 a[208:223], a[164:167], v[116:119], a[208:223]
    ds_write_b128 v4, a[184:187] offset:2048
    v_mfma_f32_32x32x16_bf16 a[208:223], a[172:175], v[124:127], a[208:223]
    ds_write_b128 v4, a[188:191] offset:3072
    v_mfma_f32_32x32x16_bf16 v[240:255], a[152:155], v[104:107], v[240:255]
    ds_write_b128 v4, a[192:195] offset:4096
    ds_write_b128 v4, a[196:199] offset:5120
    v_mfma_f32_32x32x16_bf16 v[240:255], a[160:163], v[112:115], v[240:255]
    ds_write_b128 v4, a[200:203] offset:6144
    v_mfma_f32_32x32x16_bf16 v[240:255], a[168:171], v[120:123], v[240:255]
    ds_write_b128 v4, a[204:207] offset:7168
    s_nop 3
    ds_write_b128 v4, a[208:211] offset:8192
    ds_write_b128 v4, a[212:215] offset:9216
    ds_write_b128 v4, a[216:219] offset:10240
    ds_write_b128 v4, a[220:223] offset:11264
    s_waitcnt lgkmcnt(0)
    s_barrier
    ds_read_b128 v[80:83], v44 offset:0
    ds_read_b128 v[96:99], v45 offset:0
    ds_read_b128 v[112:115], v46 offset:0
    ds_read_b64_tr_b16 v[128:129], v48 offset:0
    ds_read_b128 v[84:87], v44 offset:1024
    ds_read_b128 v[100:103], v45 offset:1024
    ds_read_b128 v[116:119], v46 offset:1024
    ds_read_b64_tr_b16 v[130:131], v48 offset:1024
    ds_read_b128 v[88:91], v44 offset:2048
    ds_read_b128 v[104:107], v45 offset:2048
    ds_read_b128 v[120:123], v46 offset:2048
    ds_read_b64_tr_b16 v[132:133], v49 offset:0
    ds_read_b128 v[92:95], v44 offset:3072
    ds_read_b128 v[108:111], v45 offset:3072
    ds_read_b128 v[124:127], v46 offset:3072
    ds_read_b64_tr_b16 v[134:135], v49 offset:1024
    s_waitcnt lgkmcnt(12)
    v_pk_add_f32 v[240:241], v[240:241], v[80:81]
    v_pk_add_f32 v[242:243], v[242:243], v[82:83]
    v_pk_add_f32 v[96:97], v[96:97], v[112:113]
    v_pk_add_f32 v[98:99], v[98:99], v[114:115]
    v_lshlrev_b32 v138, 16, v128
    v_lshlrev_b32 v146, 16, v129
    v_pk_add_f32 v[240:241], v[240:241], v[96:97]
    v_pk_add_f32 v[242:243], v[242:243], v[98:99]
    v_and_b32 v139, 0xffff0000, v128
    v_and_b32 v147, 0xffff0000, v129
    v_pk_mul_f32 v[136:137], v[240:241], v[56:57]
    v_pk_mul_f32 v[144:145], v[242:243], v[56:57]
    v_pk_mul_f32 v[240:241], v[240:241], v[138:139]
    v_pk_mul_f32 v[242:243], v[242:243], v[146:147]
    v_exp_f32 v136, v136
    v_exp_f32 v144, v144
    v_exp_f32 v137, v137
    v_exp_f32 v145, v145
    v_pk_add_f32 v[136:137], v[136:137], 1.0 op_sel_hi:[1,0]
    v_pk_add_f32 v[144:145], v[144:145], 1.0 op_sel_hi:[1,0]
    v_rcp_f32 v136, v136
    v_rcp_f32 v144, v144
    v_rcp_f32 v137, v137
    v_rcp_f32 v145, v145
    v_pk_fma_f32 v[240:241], v[240:241], v[136:137], v[200:201]
    v_pk_fma_f32 v[242:243], v[242:243], v[144:145], v[202:203]
    v_cvt_pk_bf16_f32 v152, v240, v241
    v_cvt_pk_bf16_f32 v153, v242, v243
    s_waitcnt lgkmcnt(8)
    v_pk_add_f32 v[244:245], v[244:245], v[84:85]
    v_pk_add_f32 v[246:247], v[246:247], v[86:87]
    v_pk_add_f32 v[100:101], v[100:101], v[116:117]
    v_pk_add_f32 v[102:103], v[102:103], v[118:119]
    v_lshlrev_b32 v138, 16, v130
    v_lshlrev_b32 v146, 16, v131
    v_pk_add_f32 v[244:245], v[244:245], v[100:101]
    v_pk_add_f32 v[246:247], v[246:247], v[102:103]
    v_and_b32 v139, 0xffff0000, v130
    v_and_b32 v147, 0xffff0000, v131
    v_pk_mul_f32 v[136:137], v[244:245], v[56:57]
    v_pk_mul_f32 v[144:145], v[246:247], v[56:57]
    v_pk_mul_f32 v[244:245], v[244:245], v[138:139]
    v_pk_mul_f32 v[246:247], v[246:247], v[146:147]
    v_exp_f32 v136, v136
    v_exp_f32 v144, v144
    v_exp_f32 v137, v137
    v_exp_f32 v145, v145
    v_pk_add_f32 v[136:137], v[136:137], 1.0 op_sel_hi:[1,0]
    v_pk_add_f32 v[144:145], v[144:145], 1.0 op_sel_hi:[1,0]
    v_rcp_f32 v136, v136
    v_rcp_f32 v144, v144
    v_rcp_f32 v137, v137
    v_rcp_f32 v145, v145
    v_pk_fma_f32 v[244:245], v[244:245], v[136:137], v[204:205]
    v_pk_fma_f32 v[246:247], v[246:247], v[144:145], v[206:207]
    v_cvt_pk_bf16_f32 v154, v244, v245
    v_cvt_pk_bf16_f32 v155, v246, v247
    s_nop 0
    v_permlane32_swap_b32 v152, v154
    v_permlane32_swap_b32 v153, v155
    buffer_store_dwordx4 v[152:155], v47, s[44:47], s58 offen offset:0
    s_waitcnt lgkmcnt(4)
    v_pk_add_f32 v[248:249], v[248:249], v[88:89]
    v_pk_add_f32 v[250:251], v[250:251], v[90:91]
    v_pk_add_f32 v[104:105], v[104:105], v[120:121]
    v_pk_add_f32 v[106:107], v[106:107], v[122:123]
    v_lshlrev_b32 v138, 16, v132
    v_lshlrev_b32 v146, 16, v133
    v_pk_add_f32 v[248:249], v[248:249], v[104:105]
    v_pk_add_f32 v[250:251], v[250:251], v[106:107]
    v_and_b32 v139, 0xffff0000, v132
    v_and_b32 v147, 0xffff0000, v133
    v_pk_mul_f32 v[136:137], v[248:249], v[56:57]
    v_pk_mul_f32 v[144:145], v[250:251], v[56:57]
    v_pk_mul_f32 v[248:249], v[248:249], v[138:139]
    v_pk_mul_f32 v[250:251], v[250:251], v[146:147]
    v_exp_f32 v136, v136
    v_exp_f32 v144, v144
    v_exp_f32 v137, v137
    v_exp_f32 v145, v145
    v_pk_add_f32 v[136:137], v[136:137], 1.0 op_sel_hi:[1,0]
    v_pk_add_f32 v[144:145], v[144:145], 1.0 op_sel_hi:[1,0]
    v_rcp_f32 v136, v136
    v_rcp_f32 v144, v144
    v_rcp_f32 v137, v137
    v_rcp_f32 v145, v145
    v_pk_fma_f32 v[248:249], v[248:249], v[136:137], v[208:209]
    v_pk_fma_f32 v[250:251], v[250:251], v[144:145], v[210:211]
    v_cvt_pk_bf16_f32 v156, v248, v249
    v_cvt_pk_bf16_f32 v157, v250, v251
    s_waitcnt lgkmcnt(0)
    v_pk_add_f32 v[252:253], v[252:253], v[92:93]
    v_pk_add_f32 v[254:255], v[254:255], v[94:95]
    v_pk_add_f32 v[108:109], v[108:109], v[124:125]
    v_pk_add_f32 v[110:111], v[110:111], v[126:127]
    v_lshlrev_b32 v138, 16, v134
    v_lshlrev_b32 v146, 16, v135
    v_pk_add_f32 v[252:253], v[252:253], v[108:109]
    v_pk_add_f32 v[254:255], v[254:255], v[110:111]
    v_and_b32 v139, 0xffff0000, v134
    v_and_b32 v147, 0xffff0000, v135
    v_pk_mul_f32 v[136:137], v[252:253], v[56:57]
    v_pk_mul_f32 v[144:145], v[254:255], v[56:57]
    v_pk_mul_f32 v[252:253], v[252:253], v[138:139]
    v_pk_mul_f32 v[254:255], v[254:255], v[146:147]
    v_exp_f32 v136, v136
    v_exp_f32 v144, v144
    v_exp_f32 v137, v137
    v_exp_f32 v145, v145
    v_pk_add_f32 v[136:137], v[136:137], 1.0 op_sel_hi:[1,0]
    v_pk_add_f32 v[144:145], v[144:145], 1.0 op_sel_hi:[1,0]
    v_rcp_f32 v136, v136
    v_rcp_f32 v144, v144
    v_rcp_f32 v137, v137
    v_rcp_f32 v145, v145
    v_pk_fma_f32 v[252:253], v[252:253], v[136:137], v[212:213]
    v_pk_fma_f32 v[254:255], v[254:255], v[144:145], v[214:215]
    v_cvt_pk_bf16_f32 v158, v252, v253
    v_cvt_pk_bf16_f32 v159, v254, v255
    s_nop 0
    v_permlane32_swap_b32 v156, v158
    v_permlane32_swap_b32 v157, v159
    buffer_store_dwordx4 v[156:159], v47, s[44:47], s58 offen offset:32
L_end:
    s_endpgm
.p2align 8
.type addr_table,@object
addr_table:
.long 12288,12288,152064,0,12292,12560,152080,16
.long 12296,12832,152096,32,12300,13104,152112,48
.long 12304,13376,152128,64,12308,13648,152144,80
.long 12312,13920,152160,96,12316,14192,152176,112
.long 12320,14464,152192,4096,12324,14736,152208,4112
.long 12328,15008,152224,4128,12332,15280,152240,4144
.long 12336,15552,152256,4160,12340,15824,152272,4176
.long 12344,16096,152288,4192,12348,16368,152304,4208
.long 12352,16640,152320,8192,12356,16912,152336,8208
.long 12360,17184,152352,8224,12364,17456,152368,8240
.long 12368,17728,152384,8256,12372,18000,152400,8272
.long 12376,18272,152416,8288,12380,18544,152432,8304
.long 12384,18816,152448,12288,12388,19088,152464,12304
.long 12392,19360,152480,12320,12396,19632,152496,12336
.long 12400,19904,152512,12352,12404,20176,152528,12368
.long 12408,20448,152544,12384,12412,20720,152560,12400
.long 12416,12304,152576,16384,12420,12576,152592,16400
.long 12424,12848,152608,16416,12428,13120,152624,16432
.long 12432,13392,152640,16448,12436,13664,152656,16464
.long 12440,13936,152672,16480,12444,14208,152688,16496
.long 12448,14480,152704,20480,12452,14752,152720,20496
.long 12456,15024,152736,20512,12460,15296,152752,20528
.long 12464,15568,152768,20544,12468,15840,152784,20560
.long 12472,16112,152800,20576,12476,16384,152816,20592
.long 12480,16656,152832,24576,12484,16928,152848,24592
.long 12488,17200,152864,24608,12492,17472,152880,24624
.long 12496,17744,152896,24640,12500,18016,152912,24656
.long 12504,18288,152928,24672,12508,18560,152944,24688
.long 12512,18832,152960,28672,12516,19104,152976,28688
.long 12520,19376,152992,28704,12524,19648,153008,28720
.long 12528,19920,153024,28736,12532,20192,153040,28752
.long 12536,20464,153056,28768,12540,20736,153072,28784
.long 33280,33280,152064,65536,33284,33552,152080,65552
.long 33288,33824,152096,65568,33292,34096,152112,65584
.long 33296,34368,152128,65600,33300,34640,152144,65616
.long 33304,34912,152160,65632,33308,35184,152176,65648
.long 33312,35456,152192,69632,33316,35728,152208,69648
.long 33320,36000,152224,69664,33324,36272,152240,69680
.long 33328,36544,152256,69696,33332,36816,152272,69712
.long 33336,37088,152288,69728,33340,37360,152304,69744
.long 33344,37632,152320,73728,33348,37904,152336,73744
.long 33352,38176,152352,73760,33356,38448,152368,73776
.long 33360,38720,152384,73792,33364,38992,152400,73808
.long 33368,39264,152416,73824,33372,39536,152432,73840
.long 33376,39808,152448,77824,33380,40080,152464,77840
.long 33384,40352,152480,77856,33388,40624,152496,77872
.long 33392,40896,152512,77888,33396,41168,152528,77904
.long 33400,41440,152544,77920,33404,41712,152560,77936
.long 33408,33296,152576,81920,33412,33568,152592,81936
.long 33416,33840,152608,81952,33420,34112,152624,81968
.long 33424,34384,152640,81984,33428,34656,152656,82000
.long 33432,34928,152672,82016,33436,35200,152688,82032
.long 33440,35472,152704,86016,33444,35744,152720,86032
.long 33448,36016,152736,86048,33452,36288,152752,86064
.long 33456,36560,152768,86080,33460,36832,152784,86096
.long 33464,37104,152800,86112,33468,37376,152816,86128
.long 33472,37648,152832,90112,33476,37920,152848,90128
.long 33480,38192,152864,90144,33484,38464,152880,90160
.long 33488,38736,152896,90176,33492,39008,152912,90192
.long 33496,39280,152928,90208,33500,39552,152944,90224
.long 33504,39824,152960,94208,33508,40096,152976,94224
.long 33512,40368,152992,94240,33516,40640,153008,94256
.long 33520,40912,153024,94272,33524,41184,153040,94288
.long 33528,41456,153056,94304,33532,41728,153072,94320
.long 54272,54272,156672,131072,54276,54544,156688,131088
.long 54280,54816,156704,131104,54284,55088,156720,131120
.long 54288,55360,156736,131136,54292,55632,156752,131152
.long 54296,55904,156768,131168,54300,56176,156784,131184
.long 54304,56448,156800,135168,54308,56720,156816,135184
.long 54312,56992,156832,135200,54316,57264,156848,135216
.long 54320,57536,156864,135232,54324,57808,156880,135248
.long 54328,58080,156896,135264,54332,58352,156912,135280
.long 54336,58624,156928,139264,54340,58896,156944,139280
.long 54344,59168,156960,139296,54348,59440,156976,139312
.long 54352,59712,156992,139328,54356,59984,157008,139344
.long 54360,60256,157024,139360,54364,60528,157040,139376
.long 54368,60800,157056,143360,54372,61072,157072,143376
.long 54376,61344,157088,143392,54380,61616,157104,143408
.long 54384,61888,157120,143424,54388,62160,157136,143440
.long 54392,62432,157152,143456,54396,62704,157168,143472
.long 54400,54288,157184,147456,54404,54560,157200,147472
.long 54408,54832,157216,147488,54412,55104,157232,147504
.long 54416,55376,157248,147520,54420,55648,157264,147536
.long 54424,55920,157280,147552,54428,56192,157296,147568
.long 54432,56464,157312,151552,54436,56736,157328,151568
.long 54440,57008,157344,151584,54444,57280,157360,151600
.long 54448,57552,157376,151616,54452,57824,157392,151632
.long 54456,58096,157408,151648,54460,58368,157424,151664
.long 54464,58640,157440,155648,54468,58912,157456,155664
.long 54472,59184,157472,155680,54476,59456,157488,155696
.long 54480,59728,157504,155712,54484,60000,157520,155728
.long 54488,60272,157536,155744,54492,60544,157552,155760
.long 54496,60816,157568,159744,54500,61088,157584,159760
.long 54504,61360,157600,159776,54508,61632,157616,159792
.long 54512,61904,157632,159808,54516,62176,157648,159824
.long 54520,62448,157664,159840,54524,62720,157680,159856
.long 75264,75264,156672,196608,75268,75536,156688,196624
.long 75272,75808,156704,196640,75276,76080,156720,196656
.long 75280,76352,156736,196672,75284,76624,156752,196688
.long 75288,76896,156768,196704,75292,77168,156784,196720
.long 75296,77440,156800,200704,75300,77712,156816,200720
.long 75304,77984,156832,200736,75308,78256,156848,200752
.long 75312,78528,156864,200768,75316,78800,156880,200784
.long 75320,79072,156896,200800,75324,79344,156912,200816
.long 75328,79616,156928,204800,75332,79888,156944,204816
.long 75336,80160,156960,204832,75340,80432,156976,204848
.long 75344,80704,156992,204864,75348,80976,157008,204880
.long 75352,81248,157024,204896,75356,81520,157040,204912
.long 75360,81792,157056,208896,75364,82064,157072,208912
.long 75368,82336,157088,208928,75372,82608,157104,208944
.long 75376,82880,157120,208960,75380,83152,157136,208976
.long 75384,83424,157152,208992,75388,83696,157168,209008
.long 75392,75280,157184,212992,75396,75552,157200,213008
.long 75400,75824,157216,213024,75404,76096,157232,213040
.long 75408,76368,157248,213056,75412,76640,157264,213072
.long 75416,76912,157280,213088,75420,77184,157296,213104
.long 75424,77456,157312,217088,75428,77728,157328,217104
.long 75432,78000,157344,217120,75436,78272,157360,217136
.long 75440,78544,157376,217152,75444,78816,157392,217168
.long 75448,79088,157408,217184,75452,79360,157424,217200
.long 75456,79632,157440,221184,75460,79904,157456,221200
.long 75464,80176,157472,221216,75468,80448,157488,221232
.long 75472,80720,157504,221248,75476,80992,157520,221264
.long 75480,81264,157536,221280,75484,81536,157552,221296
.long 75488,81808,157568,225280,75492,82080,157584,225296
.long 75496,82352,157600,225312,75500,82624,157616,225328
.long 75504,82896,157632,225344,75508,83168,157648,225360
.long 75512,83440,157664,225376,75516,83712,157680,225392
.long 0,15552,66784,0,16,15568,66800,8
.long 32,18240,66816,16,48,18256,66832,24
.long 64,18272,69504,96,80,18288,69520,104
.long 2752,18304,69536,112,2768,18320,69552,120
.long 2784,32000,69568,192,2800,32016,69584,200
.long 2816,32032,72256,208,2832,32048,72272,216
.long 5504,32064,72288,288,5520,32080,72304,296
.long 5536,34752,72320,304,5552,34768,72336,312
.long 5568,34784,52992,384,5584,34800,53008,392
.long 8256,34816,53024,400,8272,34832,53040,408
.long 8288,37504,53056,480,8304,37520,53072,488
.long 8320,37536,55744,496,8336,37552,55760,504
.long 22016,37568,55776,576,22032,37584,55792,584
.long 22048,40256,55808,592,22064,40272,55824,600
.long 22080,40288,58496,672,22096,40304,58512,680
.long 24768,40320,58528,688,24784,40336,58544,696
.long 24800,43008,58560,1536,24816,43024,58576,1544
.long 24832,43040,61248,1552,24848,43056,61264,1560
.long 27520,43072,61280,1632,27536,43088,61296,1640
.long 27552,45760,61312,1648,27568,45776,61328,1656
.long 27584,45792,75008,1728,27600,45808,75024,1736
.long 30272,45824,75040,1744,30288,45840,75056,1752
.long 30304,48512,75072,1824,30320,48528,75088,1832
.long 30336,48544,77760,1840,30352,48560,77776,1848
.long 11008,48576,77792,1920,11024,48592,77808,1928
.long 11040,51264,77824,1936,11056,51280,77840,1944
.long 11072,51296,80512,2016,11088,51312,80528,2024
.long 13760,51328,80544,2032,13776,51344,80560,2040
.long 13792,65024,80576,2112,13808,65040,80592,2120
.long 13824,65056,83264,2128,13840,65072,83280,2136
.long 16512,65088,83296,2208,16528,65104,83312,2216
.long 16544,67776,83328,2224,16560,67792,83344,2232
.long 96,15648,66880,20992,112,15664,66896,21000
.long 128,18336,66912,21008,144,18352,66928,21016
.long 160,18368,69600,21088,176,18384,69616,21096
.long 2848,18400,69632,21104,2864,18416,69648,21112
.long 2880,32096,69664,21184,2896,32112,69680,21192
.long 2912,32128,72352,21200,2928,32144,72368,21208
.long 5600,32160,72384,21280,5616,32176,72400,21288
.long 5632,34848,72416,21296,5648,34864,72432,21304
.long 5664,34880,53088,21376,5680,34896,53104,21384
.long 8352,34912,53120,21392,8368,34928,53136,21400
.long 8384,37600,53152,21472,8400,37616,53168,21480
.long 8416,37632,55840,21488,8432,37648,55856,21496
.long 22112,37664,55872,21568,22128,37680,55888,21576
.long 22144,40352,55904,21584,22160,40368,55920,21592
.long 22176,40384,58592,21664,22192,40400,58608,21672
.long 24864,40416,58624,21680,24880,40432,58640,21688
.long 24896,43104,58656,22528,24912,43120,58672,22536
.long 24928,43136,61344,22544,24944,43152,61360,22552
.long 27616,43168,61376,22624,27632,43184,61392,22632
.long 27648,45856,61408,22640,27664,45872,61424,22648
.long 27680,45888,75104,22720,27696,45904,75120,22728
.long 30368,45920,75136,22736,30384,45936,75152,22744
.long 30400,48608,75168,22816,30416,48624,75184,22824
.long 30432,48640,77856,22832,30448,48656,77872,22840
.long 11104,48672,77888,22912,11120,48688,77904,22920
.long 11136,51360,77920,22928,11152,51376,77936,22936
.long 11168,51392,80608,23008,11184,51408,80624,23016
.long 13856,51424,80640,23024,13872,51440,80656,23032
.long 13888,65120,80672,23104,13904,65136,80688,23112
.long 13920,65152,83360,23120,13936,65168,83376,23128
.long 16608,65184,83392,23200,16624,65200,83408,23208
.long 16640,67872,83424,23216,16656,67888,83440,23224
.long 192,15744,66976,41984,208,15760,66992,41992
.long 224,18432,67008,42000,240,18448,67024,42008
.long 256,18464,69696,42080,272,18480,69712,42088
.long 2944,18496,69728,42096,2960,18512,69744,42104
.long 2976,32192,69760,42176,2992,32208,69776,42184
.long 3008,32224,72448,42192,3024,32240,72464,42200
.long 5696,32256,72480,42272,5712,32272,72496,42280
.long 5728,34944,72512,42288,5744,34960,72528,42296
.long 5760,34976,53184,42368,5776,34992,53200,42376
.long 8448,35008,53216,42384,8464,35024,53232,42392
.long 8480,37696,53248,42464,8496,37712,53264,42472
.long 8512,37728,55936,42480,8528,37744,55952,42488
.long 22208,37760,55968,42560,22224,37776,55984,42568
.long 22240,40448,56000,42576,22256,40464,56016,42584
.long 22272,40480,58688,42656,22288,40496,58704,42664
.long 24960,40512,58720,42672,24976,40528,58736,42680
.long 24992,43200,58752,43520,25008,43216,58768,43528
.long 25024,43232,61440,43536,25040,43248,61456,43544
.long 27712,43264,61472,43616,27728,43280,61488,43624
.long 27744,45952,61504,43632,27760,45968,61520,43640
.long 27776,45984,75200,43712,27792,46000,75216,43720
.long 30464,46016,75232,43728,30480,46032,75248,43736
.long 30496,48704,75264,43808,30512,48720,75280,43816
.long 30528,48736,77952,43824,30544,48752,77968,43832
.long 11200,48768,77984,43904,11216,48784,78000,43912
.long 11232,51456,78016,43920,11248,51472,78032,43928
.long 11264,51488,80704,44000,11280,51504,80720,44008
.long 13952,51520,80736,44016,13968,51536,80752,44024
.long 13984,65216,80768,44096,14000,65232,80784,44104
.long 14016,65248,83456,44112,14032,65264,83472,44120
.long 16704,65280,83488,44192,16720,65296,83504,44200
.long 16736,67968,83520,44208,16752,67984,83536,44216
.long 288,1073741824,67072,62976,304,1073741824,67088,62984
.long 320,18528,1073741824,62992,336,18544,1073741824,63000
.long 1073741824,18560,69792,63072,1073741824,18576,69808,63080
.long 3040,1073741824,69824,63088,3056,1073741824,69840,63096
.long 3072,32288,1073741824,63168,3088,32304,1073741824,63176
.long 1073741824,32320,72544,63184,1073741824,32336,72560,63192
.long 5792,1073741824,72576,63264,5808,1073741824,72592,63272
.long 5824,35040,1073741824,63280,5840,35056,1073741824,63288
.long 1073741824,35072,53280,63360,1073741824,35088,53296,63368
.long 8544,1073741824,53312,63376,8560,1073741824,53328,63384
.long 8576,37792,1073741824,63456,8592,37808,1073741824,63464
.long 1073741824,37824,56032,63472,1073741824,37840,56048,63480
.long 22304,1073741824,56064,63552,22320,1073741824,56080,63560
.long 22336,40544,1073741824,63568,22352,40560,1073741824,63576
.long 1073741824,40576,58784,63648,1073741824,40592,58800,63656
.long 25056,1073741824,58816,63664,25072,1073741824,58832,63672
.long 25088,43296,1073741824,64512,25104,43312,1073741824,64520
.long 1073741824,43328,61536,64528,1073741824,43344,61552,64536
.long 27808,1073741824,61568,64608,27824,1073741824,61584,64616
.long 27840,46048,1073741824,64624,27856,46064,1073741824,64632
.long 1073741824,46080,75296,64704,1073741824,46096,75312,64712
.long 30560,1073741824,75328,64720,30576,1073741824,75344,64728
.long 30592,48800,1073741824,64800,30608,48816,1073741824,64808
.long 1073741824,48832,78048,64816,1073741824,48848,78064,64824
.long 11296,1073741824,78080,64896,11312,1073741824,78096,64904
.long 11328,51552,1073741824,64912,11344,51568,1073741824,64920
.long 1073741824,51584,80800,64992,1073741824,51600,80816,65000
.long 14048,1073741824,80832,65008,14064,1073741824,80848,65016
.long 14080,65312,1073741824,65088,14096,65328,1073741824,65096
.long 1073741824,65344,83552,65104,1073741824,65360,83568,65112
.long 16800,1073741824,83584,65184,16816,1073741824,83600,65192
.long 16832,68064,1073741824,65200,16848,68080,1073741824,65208
.long 83968,83968,83968,151552,85024,85024,83976,151552
.long 86080,86080,83984,151552,87136,87136,83992,151552
.long 88192,88192,85024,151552,89248,89248,85032,151552
.long 90304,90304,85040,151552,91360,91360,85048,151552
.long 92416,92416,86080,151552,93472,93472,86088,151552
.long 94528,94528,86096,151552,95584,95584,86104,151552
.long 96640,96640,87136,151552,97696,97696,87144,151552
.long 98752,98752,87152,151552,99808,99808,87160,151552
.long 83984,83984,92416,151584,85040,85040,92424,151584
.long 86096,86096,92432,151584,87152,87152,92440,151584
.long 88208,88208,93472,151584,89264,89264,93480,151584
.long 90320,90320,93488,151584,91376,91376,93496,151584
.long 92432,92432,94528,151584,93488,93488,94536,151584
.long 94544,94544,94544,151584,95600,95600,94552,151584
.long 96656,96656,95584,151584,97712,97712,95592,151584
.long 98768,98768,95600,151584,99824,99824,95608,151584
.long 84000,84000,100864,151616,85056,85056,100872,151616
.long 86112,86112,100880,151616,87168,87168,100888,151616
.long 88224,88224,101920,151616,89280,89280,101928,151616
.long 90336,90336,101936,151616,91392,91392,101944,151616
.long 92448,92448,102976,151616,93504,93504,102984,151616
.long 94560,94560,102992,151616,95616,95616,103000,151616
.long 96672,96672,104032,151616,97728,97728,104040,151616
.long 98784,98784,104048,151616,99840,99840,104056,151616
.long 84016,84016,109312,151648,85072,85072,109320,151648
.long 86128,86128,109328,151648,87184,87184,109336,151648
.long 88240,88240,110368,151648,89296,89296,110376,151648
.long 90352,90352,110384,151648,91408,91408,110392,151648
.long 92464,92464,111424,151648,93520,93520,111432,151648
.long 94576,94576,111440,151648,95632,95632,111448,151648
.long 96688,96688,112480,151648,97744,97744,112488,151648
.long 98800,98800,112496,151648,99856,99856,112504,151648
.long 83968,100864,84000,151552,85024,101920,84008,151552
.long 86080,102976,84016,151552,87136,104032,84024,151552
.long 88192,105088,85056,151552,89248,106144,85064,151552
.long 90304,107200,85072,151552,91360,108256,85080,151552
.long 92416,109312,86112,151552,93472,110368,86120,151552
.long 94528,111424,86128,151552,95584,112480,86136,151552
.long 96640,113536,87168,151552,97696,114592,87176,151552
.long 98752,115648,87184,151552,99808,116704,87192,151552
.long 83984,100880,92448,151584,85040,101936,92456,151584
.long 86096,102992,92464,151584,87152,104048,92472,151584
.long 88208,105104,93504,151584,89264,106160,93512,151584
.long 90320,107216,93520,151584,91376,108272,93528,151584
.long 92432,109328,94560,151584,93488,110384,94568,151584
.long 94544,111440,94576,151584,95600,112496,94584,151584
.long 96656,113552,95616,151584,97712,114608,95624,151584
.long 98768,115664,95632,151584,99824,116720,95640,151584
.long 84000,100896,100896,151616,85056,101952,100904,151616
.long 86112,103008,100912,151616,87168,104064,100920,151616
.long 88224,105120,101952,151616,89280,106176,101960,151616
.long 90336,107232,101968,151616,91392,108288,101976,151616
.long 92448,109344,103008,151616,93504,110400,103016,151616
.long 94560,111456,103024,151616,95616,112512,103032,151616
.long 96672,113568,104064,151616,97728,114624,104072,151616
.long 98784,115680,104080,151616,99840,116736,104088,151616
.long 84016,100912,109344,151648,85072,101968,109352,151648
.long 86128,103024,109360,151648,87184,104080,109368,151648
.long 88240,105136,110400,151648,89296,106192,110408,151648
.long 90352,107248,110416,151648,91408,108304,110424,151648
.long 92464,109360,111456,151648,93520,110416,111464,151648
.long 94576,111472,111472,151648,95632,112528,111480,151648
.long 96688,113584,112512,151648,97744,114640,112520,151648
.long 98800,115696,112528,151648,99856,116752,112536,151648
.long 83968,117760,84032,151552,85024,118816,84040,151552
.long 86080,119872,84048,151552,87136,120928,84056,151552
.long 88192,121984,85088,151552,89248,123040,85096,151552
.long 90304,124096,85104,151552,91360,125152,85112,151552
.long 92416,126208,86144,151552,93472,127264,86152,151552
.long 94528,128320,86160,151552,95584,129376,86168,151552
.long 96640,130432,87200,151552,97696,131488,87208,151552
.long 98752,132544,87216,151552,99808,133600,87224,151552
.long 83984,117776,92480,151584,85040,118832,92488,151584
.long 86096,119888,92496,151584,87152,120944,92504,151584
.long 88208,122000,93536,151584,89264,123056,93544,151584
.long 90320,124112,93552,151584,91376,125168,93560,151584
.long 92432,126224,94592,151584,93488,127280,94600,151584
.long 94544,128336,94608,151584,95600,129392,94616,151584
.long 96656,130448,95648,151584,97712,131504,95656,151584
.long 98768,132560,95664,151584,99824,133616,95672,151584
.long 84000,117792,100928,151616,85056,118848,100936,151616
.long 86112,119904,100944,151616,87168,120960,100952,151616
.long 88224,122016,101984,151616,89280,123072,101992,151616
.long 90336,124128,102000,151616,91392,125184,102008,151616
.long 92448,126240,103040,151616,93504,127296,103048,151616
.long 94560,128352,103056,151616,95616,129408,103064,151616
.long 96672,130464,104096,151616,97728,131520,104104,151616
.long 98784,132576,104112,151616,99840,133632,104120,151616
.long 84016,117808,109376,151648,85072,118864,109384,151648
.long 86128,119920,109392,151648,87184,120976,109400,151648
.long 88240,122032,110432,151648,89296,123088,110440,151648
.long 90352,124144,110448,151648,91408,125200,110456,151648
.long 92464,126256,111488,151648,93520,127312,111496,151648
.long 94576,128368,111504,151648,95632,129424,111512,151648
.long 96688,130480,112544,151648,97744,131536,112552,151648
.long 98800,132592,112560,151648,99856,133648,112568,151648
.long 83968,134656,84064,151552,85024,135712,84072,151552
.long 86080,136768,84080,151552,87136,137824,84088,151552
.long 88192,138880,85120,151552,89248,139936,85128,151552
.long 90304,140992,85136,151552,91360,142048,85144,151552
.long 92416,143104,86176,151552,93472,144160,86184,151552
.long 94528,145216,86192,151552,95584,146272,86200,151552
.long 96640,147328,87232,151552,97696,148384,87240,151552
.long 98752,149440,87248,151552,99808,150496,87256,151552
.long 83984,134672,92512,151584,85040,135728,92520,151584
.long 86096,136784,92528,151584,87152,137840,92536,151584
.long 88208,138896,93568,151584,89264,139952,93576,151584
.long 90320,141008,93584,151584,91376,142064,93592,151584
.long 92432,143120,94624,151584,93488,144176,94632,151584
.long 94544,145232,94640,151584,95600,146288,94648,151584
.long 96656,147344,95680,151584,97712,148400,95688,151584
.long 98768,149456,95696,151584,99824,150512,95704,151584
.long 84000,134688,100960,151616,85056,135744,100968,151616
.long 86112,136800,100976,151616,87168,137856,100984,151616
.long 88224,138912,102016,151616,89280,139968,102024,151616
.long 90336,141024,102032,151616,91392,142080,102040,151616
.long 92448,143136,103072,151616,93504,144192,103080,151616
.long 94560,145248,103088,151616,95616,146304,103096,151616
.long 96672,147360,104128,151616,97728,148416,104136,151616
.long 98784,149472,104144,151616,99840,150528,104152,151616
.long 84016,134704,109408,151648,85072,135760,109416,151648
.long 86128,136816,109424,151648,87184,137872,109432,151648
.long 88240,138928,110464,151648,89296,139984,110472,151648
.long 90352,141040,110480,151648,91408,142096,110488,151648
.long 92464,143152,111520,151648,93520,144208,111528,151648
.long 94576,145264,111536,151648,95632,146320,111544,151648
.long 96688,147376,112576,151648,97744,148432,112584,151648
.long 98800,149488,112592,151648,99856,150544,112600,151648
.long 151552,151552,0,0,151556,151556,4096,4
.long 151560,151560,8192,8,151564,151564,12288,12
.long 151568,151568,16384,16,151572,151572,20480,20
.long 151576,151576,24576,24,151580,151580,28672,28
.long 151584,151584,32768,32,151588,151588,36864,36
.long 151592,151592,40960,40,151596,151596,45056,44
.long 151600,151600,49152,48,151604,151604,53248,52
.long 151608,151608,57344,56,151612,151612,61440,60
.long 151552,151552,16,64,151556,151556,4112,68
.long 151560,151560,8208,72,151564,151564,12304,76
.long 151568,151568,16400,80,151572,151572,20496,84
.long 151576,151576,24592,88,151580,151580,28688,92
.long 151584,151584,32784,96,151588,151588,36880,100
.long 151592,151592,40976,104,151596,151596,45072,108
.long 151600,151600,49168,112,151604,151604,53264,116
.long 151608,151608,57360,120,151612,151612,61456,124
.long 151552,151552,32,128,151556,151556,4128,132
.long 151560,151560,8224,136,151564,151564,12320,140
.long 151568,151568,16416,144,151572,151572,20512,148
.long 151576,151576,24608,152,151580,151580,28704,156
.long 151584,151584,32800,160,151588,151588,36896,164
.long 151592,151592,40992,168,151596,151596,45088,172
.long 151600,151600,49184,176,151604,151604,53280,180
.long 151608,151608,57376,184,151612,151612,61472,188
.long 151552,151552,48,192,151556,151556,4144,196
.long 151560,151560,8240,200,151564,151564,12336,204
.long 151568,151568,16432,208,151572,151572,20528,212
.long 151576,151576,24624,216,151580,151580,28720,220
.long 151584,151584,32816,224,151588,151588,36912,228
.long 151592,151592,41008,232,151596,151596,45104,236
.long 151600,151600,49200,240,151604,151604,53296,244
.long 151608,151608,57392,248,151612,151612,61488,252
.long 151552,151616,65536,0,151556,151620,69632,4
.long 151560,151624,73728,8,151564,151628,77824,12
.long 151568,151632,81920,16,151572,151636,86016,20
.long 151576,151640,90112,24,151580,151644,94208,28
.long 151584,151648,98304,32,151588,151652,102400,36
.long 151592,151656,106496,40,151596,151660,110592,44
.long 151600,151664,114688,48,151604,151668,118784,52
.long 151608,151672,122880,56,151612,151676,126976,60
.long 151552,151616,65552,64,151556,151620,69648,68
.long 151560,151624,73744,72,151564,151628,77840,76
.long 151568,151632,81936,80,151572,151636,86032,84
.long 151576,151640,90128,88,151580,151644,94224,92
.long 151584,151648,98320,96,151588,151652,102416,100
.long 151592,151656,106512,104,151596,151660,110608,108
.long 151600,151664,114704,112,151604,151668,118800,116
.long 151608,151672,122896,120,151612,151676,126992,124
.long 151552,151616,65568,128,151556,151620,69664,132
.long 151560,151624,73760,136,151564,151628,77856,140
.long 151568,151632,81952,144,151572,151636,86048,148
.long 151576,151640,90144,152,151580,151644,94240,156
.long 151584,151648,98336,160,151588,151652,102432,164
.long 151592,151656,106528,168,151596,151660,110624,172
.long 151600,151664,114720,176,151604,151668,118816,180
.long 151608,151672,122912,184,151612,151676,127008,188
.long 151552,151616,65584,192,151556,151620,69680,196
.long 151560,151624,73776,200,151564,151628,77872,204
.long 151568,151632,81968,208,151572,151636,86064,212
.long 151576,151640,90160,216,151580,151644,94256,220
.long 151584,151648,98352,224,151588,151652,102448,228
.long 151592,151656,106544,232,151596,151660,110640,236
.long 151600,151664,114736,240,151604,151668,118832,244
.long 151608,151672,122928,248,151612,151676,127024,252
.long 151552,151680,131072,0,151556,151684,135168,4
.long 151560,151688,139264,8,151564,151692,143360,12
.long 151568,151696,147456,16,151572,151700,151552,20
.long 151576,151704,155648,24,151580,151708,159744,28
.long 151584,151712,163840,32,151588,151716,167936,36
.long 151592,151720,172032,40,151596,151724,176128,44
.long 151600,151728,180224,48,151604,151732,184320,52
.long 151608,151736,188416,56,151612,151740,192512,60
.long 151552,151680,131088,64,151556,151684,135184,68
.long 151560,151688,139280,72,151564,151692,143376,76
.long 151568,151696,147472,80,151572,151700,151568,84
.long 151576,151704,155664,88,151580,151708,159760,92
.long 151584,151712,163856,96,151588,151716,167952,100
.long 151592,151720,172048,104,151596,151724,176144,108
.long 151600,151728,180240,112,151604,151732,184336,116
.long 151608,151736,188432,120,151612,151740,192528,124
.long 151552,151680,131104,128,151556,151684,135200,132
.long 151560,151688,139296,136,151564,151692,143392,140
.long 151568,151696,147488,144,151572,151700,151584,148
.long 151576,151704,155680,152,151580,151708,159776,156
.long 151584,151712,163872,160,151588,151716,167968,164
.long 151592,151720,172064,168,151596,151724,176160,172
.long 151600,151728,180256,176,151604,151732,184352,180
.long 151608,151736,188448,184,151612,151740,192544,188
.long 151552,151680,131120,192,151556,151684,135216,196
.long 151560,151688,139312,200,151564,151692,143408,204
.long 151568,151696,147504,208,151572,151700,151600,212
.long 151576,151704,155696,216,151580,151708,159792,220
.long 151584,151712,163888,224,151588,151716,167984,228
.long 151592,151720,172080,232,151596,151724,176176,236
.long 151600,151728,180272,240,151604,151732,184368,244
.long 151608,151736,188464,248,151612,151740,192560,252
.long 151552,151744,196608,0,151556,151748,200704,4
.long 151560,151752,204800,8,151564,151756,208896,12
.long 151568,151760,212992,16,151572,151764,217088,20
.long 151576,151768,221184,24,151580,151772,225280,28
.long 151584,151776,229376,32,151588,151780,233472,36
.long 151592,151784,237568,40,151596,151788,241664,44
.long 151600,151792,245760,48,151604,151796,249856,52
.long 151608,151800,253952,56,151612,151804,258048,60
.long 151552,151744,196624,64,151556,151748,200720,68
.long 151560,151752,204816,72,151564,151756,208912,76
.long 151568,151760,213008,80,151572,151764,217104,84
.long 151576,151768,221200,88,151580,151772,225296,92
.long 151584,151776,229392,96,151588,151780,233488,100
.long 151592,151784,237584,104,151596,151788,241680,108
.long 151600,151792,245776,112,151604,151796,249872,116
.long 151608,151800,253968,120,151612,151804,258064,124
.long 151552,151744,196640,128,151556,151748,200736,132
.long 151560,151752,204832,136,151564,151756,208928,140
.long 151568,151760,213024,144,151572,151764,217120,148
.long 151576,151768,221216,152,151580,151772,225312,156
.long 151584,151776,229408,160,151588,151780,233504,164
.long 151592,151784,237600,168,151596,151788,241696,172
.long 151600,151792,245792,176,151604,151796,249888,180
.long 151608,151800,253984,184,151612,151804,258080,188
.long 151552,151744,196656,192,151556,151748,200752,196
.long 151560,151752,204848,200,151564,151756,208944,204
.long 151568,151760,213040,208,151572,151764,217136,212
.long 151576,151768,221232,216,151580,151772,225328,220
.long 151584,151776,229424,224,151588,151780,233520,228
.long 151592,151784,237616,232,151596,151788,241712,236
.long 151600,151792,245808,240,151604,151796,249904,244
.long 151608,151800,254000,248,151612,151804,258096,252
.long 91488,90464,89440,88416,87324,86300,85276,84252
.long 91484,90460,89436,88412,87320,86296,85272,84248
.long 91480,90456,89432,88408,87316,86292,85268,84244
.long 91476,90452,89428,88404,87312,86288,85264,84240
.long 91472,90448,89424,88400,87308,86284,85260,84236
.long 91468,90444,89420,88396,87304,86280,85256,84232
.long 91464,90440,89416,88392,87300,86276,85252,84228
.long 91460,90436,89412,88388,87296,86272,85248,84224
.long 91504,90480,89456,88432,87340,86316,85292,84268
.long 91500,90476,89452,88428,87336,86312,85288,84264
.long 91496,90472,89448,88424,87332,86308,85284,84260
.long 91492,90468,89444,88420,87328,86304,85280,84256
.long 91488,90464,89440,88416,87324,86300,85276,84252
.long 91484,90460,89436,88412,87320,86296,85272,84248
.long 91480,90456,89432,88408,87316,86292,85268,84244
.long 91476,90452,89428,88404,87312,86288,85264,84240
.long 91520,90496,89472,88448,87356,86332,85308,84284
.long 91516,90492,89468,88444,87352,86328,85304,84280
.long 91512,90488,89464,88440,87348,86324,85300,84276
.long 91508,90484,89460,88436,87344,86320,85296,84272
.long 91504,90480,89456,88432,87340,86316,85292,84268
.long 91500,90476,89452,88428,87336,86312,85288,84264
.long 91496,90472,89448,88424,87332,86308,85284,84260
.long 91492,90468,89444,88420,87328,86304,85280,84256
.long 91536,90512,89488,88464,87372,86348,85324,84300
.long 91532,90508,89484,88460,87368,86344,85320,84296
.long 91528,90504,89480,88456,87364,86340,85316,84292
.long 91524,90500,89476,88452,87360,86336,85312,84288
.long 91520,90496,89472,88448,87356,86332,85308,84284
.long 91516,90492,89468,88444,87352,86328,85304,84280
.long 91512,90488,89464,88440,87348,86324,85300,84276
.long 91508,90484,89460,88436,87344,86320,85296,84272
.long 91232,90208,89184,88160,87068,86044,85020,83996
.long 91228,90204,89180,88156,87064,86040,85016,83992
.long 91224,90200,89176,88152,87060,86036,85012,83988
.long 91220,90196,89172,88148,87056,86032,85008,83984
.long 91216,90192,89168,88144,87052,86028,85004,83980
.long 91212,90188,89164,88140,87048,86024,85000,83976
.long 91208,90184,89160,88136,87044,86020,84996,83972
.long 91204,90180,89156,88132,87040,86016,84992,83968
.long 91248,90224,89200,88176,87084,86060,85036,84012
.long 91244,90220,89196,88172,87080,86056,85032,84008
.long 91240,90216,89192,88168,87076,86052,85028,84004
.long 91236,90212,89188,88164,87072,86048,85024,84000
.long 91232,90208,89184,88160,87068,86044,85020,83996
.long 91228,90204,89180,88156,87064,86040,85016,83992
.long 91224,90200,89176,88152,87060,86036,85012,83988
.long 91220,90196,89172,88148,87056,86032,85008,83984
.long 91264,90240,89216,88192,87100,86076,85052,84028
.long 91260,90236,89212,88188,87096,86072,85048,84024
.long 91256,90232,89208,88184,87092,86068,85044,84020
.long 91252,90228,89204,88180,87088,86064,85040,84016
.long 91248,90224,89200,88176,87084,86060,85036,84012
.long 91244,90220,89196,88172,87080,86056,85032,84008
.long 91240,90216,89192,88168,87076,86052,85028,84004
.long 91236,90212,89188,88164,87072,86048,85024,84000
.long 91280,90256,89232,88208,87116,86092,85068,84044
.long 91276,90252,89228,88204,87112,86088,85064,84040
.long 91272,90248,89224,88200,87108,86084,85060,84036
.long 91268,90244,89220,88196,87104,86080,85056,84032
.long 91264,90240,89216,88192,87100,86076,85052,84028
.long 91260,90236,89212,88188,87096,86072,85048,84024
.long 91256,90232,89208,88184,87092,86068,85044,84020
.long 91252,90228,89204,88180,87088,86064,85040,84016
.long 100192,99168,98144,97120,96028,95004,93980,92956
.long 100188,99164,98140,97116,96024,95000,93976,92952
.long 100184,99160,98136,97112,96020,94996,93972,92948
.long 100180,99156,98132,97108,96016,94992,93968,92944
.long 100176,99152,98128,97104,96012,94988,93964,92940
.long 100172,99148,98124,97100,96008,94984,93960,92936
.long 100168,99144,98120,97096,96004,94980,93956,92932
.long 100164,99140,98116,97092,96000,94976,93952,92928
.long 100208,99184,98160,97136,96044,95020,93996,92972
.long 100204,99180,98156,97132,96040,95016,93992,92968
.long 100200,99176,98152,97128,96036,95012,93988,92964
.long 100196,99172,98148,97124,96032,95008,93984,92960
.long 100192,99168,98144,97120,96028,95004,93980,92956
.long 100188,99164,98140,97116,96024,95000,93976,92952
.long 100184,99160,98136,97112,96020,94996,93972,92948
.long 100180,99156,98132,97108,96016,94992,93968,92944
.long 100224,99200,98176,97152,96060,95036,94012,92988
.long 100220,99196,98172,97148,96056,95032,94008,92984
.long 100216,99192,98168,97144,96052,95028,94004,92980
.long 100212,99188,98164,97140,96048,95024,94000,92976
.long 100208,99184,98160,97136,96044,95020,93996,92972
.long 100204,99180,98156,97132,96040,95016,93992,92968
.long 100200,99176,98152,97128,96036,95012,93988,92964
.long 100196,99172,98148,97124,96032,95008,93984,92960
.long 100240,99216,98192,97168,96076,95052,94028,93004
.long 100236,99212,98188,97164,96072,95048,94024,93000
.long 100232,99208,98184,97160,96068,95044,94020,92996
.long 100228,99204,98180,97156,96064,95040,94016,92992
.long 100224,99200,98176,97152,96060,95036,94012,92988
.long 100220,99196,98172,97148,96056,95032,94008,92984
.long 100216,99192,98168,97144,96052,95028,94004,92980
.long 100212,99188,98164,97140,96048,95024,94000,92976
.long 99936,98912,97888,96864,95772,94748,93724,92700
.long 99932,98908,97884,96860,95768,94744,93720,92696
.long 99928,98904,97880,96856,95764,94740,93716,92692
.long 99924,98900,97876,96852,95760,94736,93712,92688
.long 99920,98896,97872,96848,95756,94732,93708,92684
.long 99916,98892,97868,96844,95752,94728,93704,92680
.long 99912,98888,97864,96840,95748,94724,93700,92676
.long 99908,98884,97860,96836,95744,94720,93696,92672
.long 99952,98928,97904,96880,95788,94764,93740,92716
.long 99948,98924,97900,96876,95784,94760,93736,92712
.long 99944,98920,97896,96872,95780,94756,93732,92708
.long 99940,98916,97892,96868,95776,94752,93728,92704
.long 99936,98912,97888,96864,95772,94748,93724,92700
.long 99932,98908,97884,96860,95768,94744,93720,92696
.long 99928,98904,97880,96856,95764,94740,93716,92692
.long 99924,98900,97876,96852,95760,94736,93712,92688
.long 99968,98944,97920,96896,95804,94780,93756,92732
.long 99964,98940,97916,96892,95800,94776,93752,92728
.long 99960,98936,97912,96888,95796,94772,93748,92724
.long 99956,98932,97908,96884,95792,94768,93744,92720
.long 99952,98928,97904,96880,95788,94764,93740,92716
.long 99948,98924,97900,96876,95784,94760,93736,92712
.long 99944,98920,97896,96872,95780,94756,93732,92708
.long 99940,98916,97892,96868,95776,94752,93728,92704
.long 99984,98960,97936,96912,95820,94796,93772,92748
.long 99980,98956,97932,96908,95816,94792,93768,92744
.long 99976,98952,97928,96904,95812,94788,93764,92740
.long 99972,98948,97924,96900,95808,94784,93760,92736
.long 99968,98944,97920,96896,95804,94780,93756,92732
.long 99964,98940,97916,96892,95800,94776,93752,92728
.long 99960,98936,97912,96888,95796,94772,93748,92724
.long 99956,98932,97908,96884,95792,94768,93744,92720
.long 152320,101376,105472,0,152352,101392,105488,32
.long 152384,101408,105504,64,152416,101424,105520,96
.long 152448,101440,105536,128,152480,101456,105552,160
.long 152512,101472,105568,192,152544,101488,105584,224
.long 152576,101504,105600,256,152608,101520,105616,288
.long 152640,101536,105632,320,152672,101552,105648,352
.long 152704,101568,105664,384,152736,101584,105680,416
.long 152768,101600,105696,448,152800,101616,105712,480
.long 152336,101632,105728,512,152368,101648,105744,544
.long 152400,101664,105760,576,152432,101680,105776,608
.long 152464,101696,105792,640,152496,101712,105808,672
.long 152528,101728,105824,704,152560,101744,105840,736
.long 152592,101760,105856,768,152624,101776,105872,800
.long 152656,101792,105888,832,152688,101808,105904,864
.long 152720,101824,105920,896,152752,101840,105936,928
.long 152784,101856,105952,960,152816,101872,105968,992
.long 152352,101888,105984,16,152384,101904,106000,48
.long 152416,101920,106016,80,152448,101936,106032,112
.long 152480,101952,106048,144,152512,101968,106064,176
.long 152544,101984,106080,208,152576,102000,106096,240
.long 152608,102016,106112,272,152640,102032,106128,304
.long 152672,102048,106144,336,152704,102064,106160,368
.long 152736,102080,106176,400,152768,102096,106192,432
.long 152800,102112,106208,464,152832,102128,106224,496
.long 152368,102144,106240,528,152400,102160,106256,560
.long 152432,102176,106272,592,152464,102192,106288,624
.long 152496,102208,106304,656,152528,102224,106320,688
.long 152560,102240,106336,720,152592,102256,106352,752
.long 152624,102272,106368,784,152656,102288,106384,816
.long 152688,102304,106400,848,152720,102320,106416,880
.long 152752,102336,106432,912,152784,102352,106448,944
.long 152816,102368,106464,976,152848,102384,106480,1008
.long 152064,105472,101376,2048,152096,105488,101392,2080
.long 152128,105504,101408,2112,152160,105520,101424,2144
.long 152192,105536,101440,2176,152224,105552,101456,2208
.long 152256,105568,101472,2240,152288,105584,101488,2272
.long 152320,105600,101504,2304,152352,105616,101520,2336
.long 152384,105632,101536,2368,152416,105648,101552,2400
.long 152448,105664,101568,2432,152480,105680,101584,2464
.long 152512,105696,101600,2496,152544,105712,101616,2528
.long 152080,105728,101632,2560,152112,105744,101648,2592
.long 152144,105760,101664,2624,152176,105776,101680,2656
.long 152208,105792,101696,2688,152240,105808,101712,2720
.long 152272,105824,101728,2752,152304,105840,101744,2784
.long 152336,105856,101760,2816,152368,105872,101776,2848
.long 152400,105888,101792,2880,152432,105904,101808,2912
.long 152464,105920,101824,2944,152496,105936,101840,2976
.long 152528,105952,101856,3008,152560,105968,101872,3040
.long 152096,105984,101888,2064,152128,106000,101904,2096
.long 152160,106016,101920,2128,152192,106032,101936,2160
.long 152224,106048,101952,2192,152256,106064,101968,2224
.long 152288,106080,101984,2256,152320,106096,102000,2288
.long 152352,106112,102016,2320,152384,106128,102032,2352
.long 152416,106144,102048,2384,152448,106160,102064,2416
.long 152480,106176,102080,2448,152512,106192,102096,2480
.long 152544,106208,102112,2512,152576,106224,102128,2544
.long 152112,106240,102144,2576,152144,106256,102160,2608
.long 152176,106272,102176,2640,152208,106288,102192,2672
.long 152240,106304,102208,2704,152272,106320,102224,2736
.long 152304,106336,102240,2768,152336,106352,102256,2800
.long 152368,106368,102272,2832,152400,106384,102288,2864
.long 152432,106400,102304,2896,152464,106416,102320,2928
.long 152496,106432,102336,2960,152528,106448,102352,2992
.long 152560,106464,102368,3024,152592,106480,102384,3056
.long 156928,109568,113664,4096,156960,109584,113680,4128
.long 156992,109600,113696,4160,157024,109616,113712,4192
.long 157056,109632,113728,4224,157088,109648,113744,4256
.long 157120,109664,113760,4288,157152,109680,113776,4320
.long 157184,109696,113792,4352,157216,109712,113808,4384
.long 157248,109728,113824,4416,157280,109744,113840,4448
.long 157312,109760,113856,4480,157344,109776,113872,4512
.long 157376,109792,113888,4544,157408,109808,113904,4576
.long 156944,109824,113920,4608,156976,109840,113936,4640
.long 157008,109856,113952,4672,157040,109872,113968,4704
.long 157072,109888,113984,4736,157104,109904,114000,4768
.long 157136,109920,114016,4800,157168,109936,114032,4832
.long 157200,109952,114048,4864,157232,109968,114064,4896
.long 157264,109984,114080,4928,157296,110000,114096,4960
.long 157328,110016,114112,4992,157360,110032,114128,5024
.long 157392,110048,114144,5056,157424,110064,114160,5088
.long 156960,110080,114176,4112,156992,110096,114192,4144
.long 157024,110112,114208,4176,157056,110128,114224,4208
.long 157088,110144,114240,4240,157120,110160,114256,4272
.long 157152,110176,114272,4304,157184,110192,114288,4336
.long 157216,110208,114304,4368,157248,110224,114320,4400
.long 157280,110240,114336,4432,157312,110256,114352,4464
.long 157344,110272,114368,4496,157376,110288,114384,4528
.long 157408,110304,114400,4560,157440,110320,114416,4592
.long 156976,110336,114432,4624,157008,110352,114448,4656
.long 157040,110368,114464,4688,157072,110384,114480,4720
.long 157104,110400,114496,4752,157136,110416,114512,4784
.long 157168,110432,114528,4816,157200,110448,114544,4848
.long 157232,110464,114560,4880,157264,110480,114576,4912
.long 157296,110496,114592,4944,157328,110512,114608,4976
.long 157360,110528,114624,5008,157392,110544,114640,5040
.long 157424,110560,114656,5072,157456,110576,114672,5104
.long 156672,113664,109568,6144,156704,113680,109584,6176
.long 156736,113696,109600,6208,156768,113712,109616,6240
.long 156800,113728,109632,6272,156832,113744,109648,6304
.long 156864,113760,109664,6336,156896,113776,109680,6368
.long 156928,113792,109696,6400,156960,113808,109712,6432
.long 156992,113824,109728,6464,157024,113840,109744,6496
.long 157056,113856,109760,6528,157088,113872,109776,6560
.long 157120,113888,109792,6592,157152,113904,109808,6624
.long 156688,113920,109824,6656,156720,113936,109840,6688
.long 156752,113952,109856,6720,156784,113968,109872,6752
.long 156816,113984,109888,6784,156848,114000,109904,6816
.long 156880,114016,109920,6848,156912,114032,109936,6880
.long 156944,114048,109952,6912,156976,114064,109968,6944
.long 157008,114080,109984,6976,157040,114096,110000,7008
.long 157072,114112,110016,7040,157104,114128,110032,7072
.long 157136,114144,110048,7104,157168,114160,110064,7136
.long 156704,114176,110080,6160,156736,114192,110096,6192
.long 156768,114208,110112,6224,156800,114224,110128,6256
.long 156832,114240,110144,6288,156864,114256,110160,6320
.long 156896,114272,110176,6352,156928,114288,110192,6384
.long 156960,114304,110208,6416,156992,114320,110224,6448
.long 157024,114336,110240,6480,157056,114352,110256,6512
.long 157088,114368,110272,6544,157120,114384,110288,6576
.long 157152,114400,110304,6608,157184,114416,110320,6640
.long 156720,114432,110336,6672,156752,114448,110352,6704
.long 156784,114464,110368,6736,156816,114480,110384,6768
.long 156848,114496,110400,6800,156880,114512,110416,6832
.long 156912,114528,110432,6864,156944,114544,110448,6896
.long 156976,114560,110464,6928,157008,114576,110480,6960
.long 157040,114592,110496,6992,157072,114608,110512,7024
.long 157104,114624,110528,7056,157136,114640,110544,7088
.long 157168,114656,110560,7120,157200,114672,110576,7152
.long 117760,117824,85488,87024,117768,117832,85472,87008
.long 117776,117840,85456,86992,117784,117848,85440,86976
.long 117888,117952,85424,86960,117896,117960,85408,86944
.long 117904,117968,85392,86928,117912,117976,85376,86912
.long 118080,118016,85360,86896,118088,118024,85344,86880
.long 118096,118032,85328,86864,118104,118040,85312,86848
.long 118208,118144,85296,86832,118216,118152,85280,86816
.long 118224,118160,85264,86800,118232,118168,85248,86784
.long 117792,117856,85232,86768,117800,117864,85216,86752
.long 117808,117872,85200,86736,117816,117880,85184,86720
.long 117920,117984,85168,86704,117928,117992,85152,86688
.long 117936,118000,85136,86672,117944,118008,85120,86656
.long 118112,118048,85104,86640,118120,118056,85088,86624
.long 118128,118064,85072,86608,118136,118072,85056,86592
.long 118240,118176,85040,86576,118248,118184,85024,86560
.long 118256,118192,85008,86544,118264,118200,84992,86528
.long 118784,118848,84464,86512,118792,118856,84448,86496
.long 118800,118864,84432,86480,118808,118872,84416,86464
.long 118912,118976,84400,86448,118920,118984,84384,86432
.long 118928,118992,84368,86416,118936,119000,84352,86400
.long 119104,119040,84336,86384,119112,119048,84320,86368
.long 119120,119056,84304,86352,119128,119064,84288,86336
.long 119232,119168,84272,86320,119240,119176,84256,86304
.long 119248,119184,84240,86288,119256,119192,84224,86272
.long 118816,118880,84208,86256,118824,118888,84192,86240
.long 118832,118896,84176,86224,118840,118904,84160,86208
.long 118944,119008,84144,86192,118952,119016,84128,86176
.long 118960,119024,84112,86160,118968,119032,84096,86144
.long 119136,119072,84080,86128,119144,119080,84064,86112
.long 119152,119088,84048,86096,119160,119096,84032,86080
.long 119264,119200,84016,86064,119272,119208,84000,86048
.long 119280,119216,83984,86032,119288,119224,83968,86016
.long 125952,126016,85488,87024,125960,126024,85472,87008
.long 125968,126032,85456,86992,125976,126040,85440,86976
.long 126080,126144,85424,86960,126088,126152,85408,86944
.long 126096,126160,85392,86928,126104,126168,85376,86912
.long 126272,126208,85360,86896,126280,126216,85344,86880
.long 126288,126224,85328,86864,126296,126232,85312,86848
.long 126400,126336,85296,86832,126408,126344,85280,86816
.long 126416,126352,85264,86800,126424,126360,85248,86784
.long 125984,126048,85232,86768,125992,126056,85216,86752
.long 126000,126064,85200,86736,126008,126072,85184,86720
.long 126112,126176,85168,86704,126120,126184,85152,86688
.long 126128,126192,85136,86672,126136,126200,85120,86656
.long 126304,126240,85104,86640,126312,126248,85088,86624
.long 126320,126256,85072,86608,126328,126264,85056,86592
.long 126432,126368,85040,86576,126440,126376,85024,86560
.long 126448,126384,85008,86544,126456,126392,84992,86528
.long 126976,127040,84464,86512,126984,127048,84448,86496
.long 126992,127056,84432,86480,127000,127064,84416,86464
.long 127104,127168,84400,86448,127112,127176,84384,86432
.long 127120,127184,84368,86416,127128,127192,84352,86400
.long 127296,127232,84336,86384,127304,127240,84320,86368
.long 127312,127248,84304,86352,127320,127256,84288,86336
.long 127424,127360,84272,86320,127432,127368,84256,86304
.long 127440,127376,84240,86288,127448,127384,84224,86272
.long 127008,127072,84208,86256,127016,127080,84192,86240
.long 127024,127088,84176,86224,127032,127096,84160,86208
.long 127136,127200,84144,86192,127144,127208,84128,86176
.long 127152,127216,84112,86160,127160,127224,84096,86144
.long 127328,127264,84080,86128,127336,127272,84064,86112
.long 127344,127280,84048,86096,127352,127288,84032,86080
.long 127456,127392,84016,86064,127464,127400,84000,86048
.long 127472,127408,83984,86032,127480,127416,83968,86016
.long 134208,134144,94192,95728,134216,134152,94176,95712
.long 134224,134160,94160,95696,134232,134168,94144,95680
.long 134336,134272,94128,95664,134344,134280,94112,95648
.long 134352,134288,94096,95632,134360,134296,94080,95616
.long 134400,134464,94064,95600,134408,134472,94048,95584
.long 134416,134480,94032,95568,134424,134488,94016,95552
.long 134528,134592,94000,95536,134536,134600,93984,95520
.long 134544,134608,93968,95504,134552,134616,93952,95488
.long 134240,134176,93936,95472,134248,134184,93920,95456
.long 134256,134192,93904,95440,134264,134200,93888,95424
.long 134368,134304,93872,95408,134376,134312,93856,95392
.long 134384,134320,93840,95376,134392,134328,93824,95360
.long 134432,134496,93808,95344,134440,134504,93792,95328
.long 134448,134512,93776,95312,134456,134520,93760,95296
.long 134560,134624,93744,95280,134568,134632,93728,95264
.long 134576,134640,93712,95248,134584,134648,93696,95232
.long 135232,135168,93168,95216,135240,135176,93152,95200
.long 135248,135184,93136,95184,135256,135192,93120,95168
.long 135360,135296,93104,95152,135368,135304,93088,95136
.long 135376,135312,93072,95120,135384,135320,93056,95104
.long 135424,135488,93040,95088,135432,135496,93024,95072
.long 135440,135504,93008,95056,135448,135512,92992,95040
.long 135552,135616,92976,95024,135560,135624,92960,95008
.long 135568,135632,92944,94992,135576,135640,92928,94976
.long 135264,135200,92912,94960,135272,135208,92896,94944
.long 135280,135216,92880,94928,135288,135224,92864,94912
.long 135392,135328,92848,94896,135400,135336,92832,94880
.long 135408,135344,92816,94864,135416,135352,92800,94848
.long 135456,135520,92784,94832,135464,135528,92768,94816
.long 135472,135536,92752,94800,135480,135544,92736,94784
.long 135584,135648,92720,94768,135592,135656,92704,94752
.long 135600,135664,92688,94736,135608,135672,92672,94720
.long 142400,142336,94192,95728,142408,142344,94176,95712
.long 142416,142352,94160,95696,142424,142360,94144,95680
.long 142528,142464,94128,95664,142536,142472,94112,95648
.long 142544,142480,94096,95632,142552,142488,94080,95616
.long 142592,142656,94064,95600,142600,142664,94048,95584
.long 142608,142672,94032,95568,142616,142680,94016,95552
.long 142720,142784,94000,95536,142728,142792,93984,95520
.long 142736,142800,93968,95504,142744,142808,93952,95488
.long 142432,142368,93936,95472,142440,142376,93920,95456
.long 142448,142384,93904,95440,142456,142392,93888,95424
.long 142560,142496,93872,95408,142568,142504,93856,95392
.long 142576,142512,93840,95376,142584,142520,93824,95360
.long 142624,142688,93808,95344,142632,142696,93792,95328
.long 142640,142704,93776,95312,142648,142712,93760,95296
.long 142752,142816,93744,95280,142760,142824,93728,95264
.long 142768,142832,93712,95248,142776,142840,93696,95232
.long 143424,143360,93168,95216,143432,143368,93152,95200
.long 143440,143376,93136,95184,143448,143384,93120,95168
.long 143552,143488,93104,95152,143560,143496,93088,95136
.long 143568,143504,93072,95120,143576,143512,93056,95104
.long 143616,143680,93040,95088,143624,143688,93024,95072
.long 143632,143696,93008,95056,143640,143704,92992,95040
.long 143744,143808,92976,95024,143752,143816,92960,95008
.long 143760,143824,92944,94992,143768,143832,92928,94976
.long 143456,143392,92912,94960,143464,143400,92896,94944
.long 143472,143408,92880,94928,143480,143416,92864,94912
.long 143584,143520,92848,94896,143592,143528,92832,94880
.long 143600,143536,92816,94864,143608,143544,92800,94848
.long 143648,143712,92784,94832,143656,143720,92768,94816
.long 143664,143728,92752,94800,143672,143736,92736,94784
.long 143776,143840,92720,94768,143784,143848,92704,94752
.long 143792,143856,92688,94736,143800,143864,92672,94720
.long 20992,46080,71168,0,21008,46096,71184,1024
.long 21024,46112,71200,2048,21040,46128,71216,3072
.long 21056,46144,71232,4096,21072,46160,71248,5120
.long 21088,46176,71264,6144,21104,46192,71280,7168
.long 21120,46208,71296,8192,21136,46224,71312,9216
.long 21152,46240,71328,10240,21168,46256,71344,11264
.long 21184,46272,71360,12288,21200,46288,71376,13312
.long 21216,46304,71392,14336,21232,46320,71408,15360
.long 21248,46336,71424,16384,21264,46352,71440,17408
.long 21280,46368,71456,18432,21296,46384,71472,19456
.long 21312,46400,71488,20480,21328,46416,71504,21504
.long 21344,46432,71520,22528,21360,46448,71536,23552
.long 21376,46464,71552,24576,21392,46480,71568,25600
.long 21408,46496,71584,26624,21424,46512,71600,27648
.long 21440,46528,71616,28672,21456,46544,71632,29696
.long 21472,46560,71648,30720,21488,46576,71664,31744
.long 21504,46592,71680,16,21520,46608,71696,1040
.long 21536,46624,71712,2064,21552,46640,71728,3088
.long 21568,46656,71744,4112,21584,46672,71760,5136
.long 21600,46688,71776,6160,21616,46704,71792,7184
.long 21632,46720,71808,8208,21648,46736,71824,9232
.long 21664,46752,71840,10256,21680,46768,71856,11280
.long 21696,46784,71872,12304,21712,46800,71888,13328
.long 21728,46816,71904,14352,21744,46832,71920,15376
.long 21760,46848,71936,16400,21776,46864,71952,17424
.long 21792,46880,71968,18448,21808,46896,71984,19472
.long 21824,46912,72000,20496,21840,46928,72016,21520
.long 21856,46944,72032,22544,21872,46960,72048,23568
.long 21888,46976,72064,24592,21904,46992,72080,25616
.long 21920,47008,72096,26640,21936,47024,72112,27664
.long 21952,47040,72128,28688,21968,47056,72144,29712
.long 21984,47072,72160,30736,22000,47088,72176,31760
.long 0,67072,50176,32768,16,67088,50192,33792
.long 32,67104,50208,34816,48,67120,50224,35840
.long 64,67136,50240,36864,80,67152,50256,37888
.long 96,67168,50272,38912,112,67184,50288,39936
.long 128,67200,50304,40960,144,67216,50320,41984
.long 160,67232,50336,43008,176,67248,50352,44032
.long 192,67264,50368,45056,208,67280,50384,46080
.long 224,67296,50400,47104,240,67312,50416,48128
.long 256,67328,50432,49152,272,67344,50448,50176
.long 288,67360,50464,51200,304,67376,50480,52224
.long 320,67392,50496,53248,336,67408,50512,54272
.long 352,67424,50528,55296,368,67440,50544,56320
.long 384,67456,50560,57344,400,67472,50576,58368
.long 416,67488,50592,59392,432,67504,50608,60416
.long 448,67520,50624,61440,464,67536,50640,62464
.long 480,67552,50656,63488,496,67568,50672,64512
.long 512,67584,50688,32784,528,67600,50704,33808
.long 544,67616,50720,34832,560,67632,50736,35856
.long 576,67648,50752,36880,592,67664,50768,37904
.long 608,67680,50784,38928,624,67696,50800,39952
.long 640,67712,50816,40976,656,67728,50832,42000
.long 672,67744,50848,43024,688,67760,50864,44048
.long 704,67776,50880,45072,720,67792,50896,46096
.long 736,67808,50912,47120,752,67824,50928,48144
.long 768,67840,50944,49168,784,67856,50960,50192
.long 800,67872,50976,51216,816,67888,50992,52240
.long 832,67904,51008,53264,848,67920,51024,54288
.long 864,67936,51040,55312,880,67952,51056,56336
.long 896,67968,51072,57360,912,67984,51088,58384
.long 928,68000,51104,59408,944,68016,51120,60432
.long 960,68032,51136,61456,976,68048,51152,62480
.long 992,68064,51168,63504,1008,68080,51184,64528
.long 62976,4096,29184,64,62992,4112,29200,1088
.long 63008,4128,29216,2112,63024,4144,29232,3136
.long 63040,4160,29248,4160,63056,4176,29264,5184
.long 63072,4192,29280,6208,63088,4208,29296,7232
.long 63104,4224,29312,8256,63120,4240,29328,9280
.long 63136,4256,29344,10304,63152,4272,29360,11328
.long 63168,4288,29376,12352,63184,4304,29392,13376
.long 63200,4320,29408,14400,63216,4336,29424,15424
.long 63232,4352,29440,16448,63248,4368,29456,17472
.long 63264,4384,29472,18496,63280,4400,29488,19520
.long 63296,4416,29504,20544,63312,4432,29520,21568
.long 63328,4448,29536,22592,63344,4464,29552,23616
.long 63360,4480,29568,24640,63376,4496,29584,25664
.long 63392,4512,29600,26688,63408,4528,29616,27712
.long 63424,4544,29632,28736,63440,4560,29648,29760
.long 63456,4576,29664,30784,63472,4592,29680,31808
.long 63488,4608,29696,80,63504,4624,29712,1104
.long 63520,4640,29728,2128,63536,4656,29744,3152
.long 63552,4672,29760,4176,63568,4688,29776,5200
.long 63584,4704,29792,6224,63600,4720,29808,7248
.long 63616,4736,29824,8272,63632,4752,29840,9296
.long 63648,4768,29856,10320,63664,4784,29872,11344
.long 63680,4800,29888,12368,63696,4816,29904,13392
.long 63712,4832,29920,14416,63728,4848,29936,15440
.long 63744,4864,29952,16464,63760,4880,29968,17488
.long 63776,4896,29984,18512,63792,4912,30000,19536
.long 63808,4928,30016,20560,63824,4944,30032,21584
.long 63840,4960,30048,22608,63856,4976,30064,23632
.long 63872,4992,30080,24656,63888,5008,30096,25680
.long 63904,5024,30112,26704,63920,5040,30128,27728
.long 63936,5056,30144,28752,63952,5072,30160,29776
.long 63968,5088,30176,30800,63984,5104,30192,31824
.long 41984,25088,8192,32832,42000,25104,8208,33856
.long 42016,25120,8224,34880,42032,25136,8240,35904
.long 42048,25152,8256,36928,42064,25168,8272,37952
.long 42080,25184,8288,38976,42096,25200,8304,40000
.long 42112,25216,8320,41024,42128,25232,8336,42048
.long 42144,25248,8352,43072,42160,25264,8368,44096
.long 42176,25280,8384,45120,42192,25296,8400,46144
.long 42208,25312,8416,47168,42224,25328,8432,48192
.long 42240,25344,8448,49216,42256,25360,8464,50240
.long 42272,25376,8480,51264,42288,25392,8496,52288
.long 42304,25408,8512,53312,42320,25424,8528,54336
.long 42336,25440,8544,55360,42352,25456,8560,56384
.long 42368,25472,8576,57408,42384,25488,8592,58432
.long 42400,25504,8608,59456,42416,25520,8624,60480
.long 42432,25536,8640,61504,42448,25552,8656,62528
.long 42464,25568,8672,63552,42480,25584,8688,64576
.long 42496,25600,8704,32848,42512,25616,8720,33872
.long 42528,25632,8736,34896,42544,25648,8752,35920
.long 42560,25664,8768,36944,42576,25680,8784,37968
.long 42592,25696,8800,38992,42608,25712,8816,40016
.long 42624,25728,8832,41040,42640,25744,8848,42064
.long 42656,25760,8864,43088,42672,25776,8880,44112
.long 42688,25792,8896,45136,42704,25808,8912,46160
.long 42720,25824,8928,47184,42736,25840,8944,48208
.long 42752,25856,8960,49232,42768,25872,8976,50256
.long 42784,25888,8992,51280,42800,25904,9008,52304
.long 42816,25920,9024,53328,42832,25936,9040,54352
.long 42848,25952,9056,55376,42864,25968,9072,56400
.long 42880,25984,9088,57424,42896,26000,9104,58448
.long 42912,26016,9120,59472,42928,26032,9136,60496
.long 42944,26048,9152,61520,42960,26064,9168,62544
.long 42976,26080,9184,63568,42992,26096,9200,64592
.long 12288,33280,0,64,12296,33288,8,72
.long 12304,33296,16,80,12312,33304,24,88
.long 12416,33408,128,192,12424,33416,136,200
.long 12432,33424,144,208,12440,33432,152,216
.long 12544,33536,320,256,12552,33544,328,264
.long 12560,33552,336,272,12568,33560,344,280
.long 12672,33664,448,384,12680,33672,456,392
.long 12688,33680,464,400,12696,33688,472,408
.long 12320,33312,32,96,12328,33320,40,104
.long 12336,33328,48,112,12344,33336,56,120
.long 12448,33440,160,224,12456,33448,168,232
.long 12464,33456,176,240,12472,33464,184,248
.long 12576,33568,352,288,12584,33576,360,296
.long 12592,33584,368,304,12600,33592,376,312
.long 12704,33696,480,416,12712,33704,488,424
.long 12720,33712,496,432,12728,33720,504,440
.long 12800,33792,1024,1088,12808,33800,1032,1096
.long 12816,33808,1040,1104,12824,33816,1048,1112
.long 12928,33920,1152,1216,12936,33928,1160,1224
.long 12944,33936,1168,1232,12952,33944,1176,1240
.long 13056,34048,1344,1280,13064,34056,1352,1288
.long 13072,34064,1360,1296,13080,34072,1368,1304
.long 13184,34176,1472,1408,13192,34184,1480,1416
.long 13200,34192,1488,1424,13208,34200,1496,1432
.long 12832,33824,1056,1120,12840,33832,1064,1128
.long 12848,33840,1072,1136,12856,33848,1080,1144
.long 12960,33952,1184,1248,12968,33960,1192,1256
.long 12976,33968,1200,1264,12984,33976,1208,1272
.long 13088,34080,1376,1312,13096,34088,1384,1320
.long 13104,34096,1392,1328,13112,34104,1400,1336
.long 13216,34208,1504,1440,13224,34216,1512,1448
.long 13232,34224,1520,1456,13240,34232,1528,1464
.long 12352,33344,20992,21056,12360,33352,21000,21064
.long 12368,33360,21008,21072,12376,33368,21016,21080
.long 12480,33472,21120,21184,12488,33480,21128,21192
.long 12496,33488,21136,21200,12504,33496,21144,21208
.long 12608,33600,21312,21248,12616,33608,21320,21256
.long 12624,33616,21328,21264,12632,33624,21336,21272
.long 12736,33728,21440,21376,12744,33736,21448,21384
.long 12752,33744,21456,21392,12760,33752,21464,21400
.long 12384,33376,21024,21088,12392,33384,21032,21096
.long 12400,33392,21040,21104,12408,33400,21048,21112
.long 12512,33504,21152,21216,12520,33512,21160,21224
.long 12528,33520,21168,21232,12536,33528,21176,21240
.long 12640,33632,21344,21280,12648,33640,21352,21288
.long 12656,33648,21360,21296,12664,33656,21368,21304
.long 12768,33760,21472,21408,12776,33768,21480,21416
.long 12784,33776,21488,21424,12792,33784,21496,21432
.long 12864,33856,22016,22080,12872,33864,22024,22088
.long 12880,33872,22032,22096,12888,33880,22040,22104
.long 12992,33984,22144,22208,13000,33992,22152,22216
.long 13008,34000,22160,22224,13016,34008,22168,22232
.long 13120,34112,22336,22272,13128,34120,22344,22280
.long 13136,34128,22352,22288,13144,34136,22360,22296
.long 13248,34240,22464,22400,13256,34248,22472,22408
.long 13264,34256,22480,22416,13272,34264,22488,22424
.long 12896,33888,22048,22112,12904,33896,22056,22120
.long 12912,33904,22064,22128,12920,33912,22072,22136
.long 13024,34016,22176,22240,13032,34024,22184,22248
.long 13040,34032,22192,22256,13048,34040,22200,22264
.long 13152,34144,22368,22304,13160,34152,22376,22312
.long 13168,34160,22384,22320,13176,34168,22392,22328
.long 13280,34272,22496,22432,13288,34280,22504,22440
.long 13296,34288,22512,22448,13304,34296,22520,22456
.long 54272,75264,42048,41984,54280,75272,42056,41992
.long 54288,75280,42064,42000,54296,75288,42072,42008
.long 54400,75392,42176,42112,54408,75400,42184,42120
.long 54416,75408,42192,42128,54424,75416,42200,42136
.long 54528,75520,42240,42304,54536,75528,42248,42312
.long 54544,75536,42256,42320,54552,75544,42264,42328
.long 54656,75648,42368,42432,54664,75656,42376,42440
.long 54672,75664,42384,42448,54680,75672,42392,42456
.long 54304,75296,42080,42016,54312,75304,42088,42024
.long 54320,75312,42096,42032,54328,75320,42104,42040
.long 54432,75424,42208,42144,54440,75432,42216,42152
.long 54448,75440,42224,42160,54456,75448,42232,42168
.long 54560,75552,42272,42336,54568,75560,42280,42344
.long 54576,75568,42288,42352,54584,75576,42296,42360
.long 54688,75680,42400,42464,54696,75688,42408,42472
.long 54704,75696,42416,42480,54712,75704,42424,42488
.long 54784,75776,43072,43008,54792,75784,43080,43016
.long 54800,75792,43088,43024,54808,75800,43096,43032
.long 54912,75904,43200,43136,54920,75912,43208,43144
.long 54928,75920,43216,43152,54936,75928,43224,43160
.long 55040,76032,43264,43328,55048,76040,43272,43336
.long 55056,76048,43280,43344,55064,76056,43288,43352
.long 55168,76160,43392,43456,55176,76168,43400,43464
.long 55184,76176,43408,43472,55192,76184,43416,43480
.long 54816,75808,43104,43040,54824,75816,43112,43048
.long 54832,75824,43120,43056,54840,75832,43128,43064
.long 54944,75936,43232,43168,54952,75944,43240,43176
.long 54960,75952,43248,43184,54968,75960,43256,43192
.long 55072,76064,43296,43360,55080,76072,43304,43368
.long 55088,76080,43312,43376,55096,76088,43320,43384
.long 55200,76192,43424,43488,55208,76200,43432,43496
.long 55216,76208,43440,43504,55224,76216,43448,43512
.long 54336,75328,63040,62976,54344,75336,63048,62984
.long 54352,75344,63056,62992,54360,75352,63064,63000
.long 54464,75456,63168,63104,54472,75464,63176,63112
.long 54480,75472,63184,63120,54488,75480,63192,63128
.long 54592,75584,63232,63296,54600,75592,63240,63304
.long 54608,75600,63248,63312,54616,75608,63256,63320
.long 54720,75712,63360,63424,54728,75720,63368,63432
.long 54736,75728,63376,63440,54744,75736,63384,63448
.long 54368,75360,63072,63008,54376,75368,63080,63016
.long 54384,75376,63088,63024,54392,75384,63096,63032
.long 54496,75488,63200,63136,54504,75496,63208,63144
.long 54512,75504,63216,63152,54520,75512,63224,63160
.long 54624,75616,63264,63328,54632,75624,63272,63336
.long 54640,75632,63280,63344,54648,75640,63288,63352
.long 54752,75744,63392,63456,54760,75752,63400,63464
.long 54768,75760,63408,63472,54776,75768,63416,63480
.long 54848,75840,64064,64000,54856,75848,64072,64008
.long 54864,75856,64080,64016,54872,75864,64088,64024
.long 54976,75968,64192,64128,54984,75976,64200,64136
.long 54992,75984,64208,64144,55000,75992,64216,64152
.long 55104,76096,64256,64320,55112,76104,64264,64328
.long 55120,76112,64272,64336,55128,76120,64280,64344
.long 55232,76224,64384,64448,55240,76232,64392,64456
.long 55248,76240,64400,64464,55256,76248,64408,64472
.long 54880,75872,64096,64032,54888,75880,64104,64040
.long 54896,75888,64112,64048,54904,75896,64120,64056
.long 55008,76000,64224,64160,55016,76008,64232,64168
.long 55024,76016,64240,64176,55032,76024,64248,64184
.long 55136,76128,64288,64352,55144,76136,64296,64360
.long 55152,76144,64304,64368,55160,76152,64312,64376
.long 55264,76256,64416,64480,55272,76264,64424,64488
.long 55280,76272,64432,64496,55288,76280,64440,64504
.long 0,1024,0,0,16,1040,16,128
.long 32,1056,32,256,48,1072,48,384
.long 64,1088,64,1024,80,1104,80,1152
.long 96,1120,96,1280,112,1136,112,1408
.long 128,1152,1024,2048,144,1168,1040,2176
.long 160,1184,1056,2304,176,1200,1072,2432
.long 192,1216,1088,3072,208,1232,1104,3200
.long 224,1248,1120,3328,240,1264,1136,3456
.long 256,1280,2112,4096,272,1296,2128,4224
.long 288,1312,2144,4352,304,1328,2160,4480
.long 320,1344,2048,5120,336,1360,2064,5248
.long 352,1376,2080,5376,368,1392,2096,5504
.long 384,1408,3136,6144,400,1424,3152,6272
.long 416,1440,3168,6400,432,1456,3184,6528
.long 448,1472,3072,7168,464,1488,3088,7296
.long 480,1504,3104,7424,496,1520,3120,7552
.long 512,1536,4096,8192,528,1552,4112,8320
.long 544,1568,4128,8448,560,1584,4144,8576
.long 576,1600,4160,9216,592,1616,4176,9344
.long 608,1632,4192,9472,624,1648,4208,9600
.long 640,1664,5120,10240,656,1680,5136,10368
.long 672,1696,5152,10496,688,1712,5168,10624
.long 704,1728,5184,11264,720,1744,5200,11392
.long 736,1760,5216,11520,752,1776,5232,11648
.long 768,1792,6208,12288,784,1808,6224,12416
.long 800,1824,6240,12544,816,1840,6256,12672
.long 832,1856,6144,13312,848,1872,6160,13440
.long 864,1888,6176,13568,880,1904,6192,13696
.long 896,1920,7232,14336,912,1936,7248,14464
.long 928,1952,7264,14592,944,1968,7280,14720
.long 960,1984,7168,15360,976,2000,7184,15488
.long 992,2016,7200,15616,1008,2032,7216,15744
.long 1024,0,360448,16384,1040,16,360464,16512
.long 1056,32,360480,16640,1072,48,360496,16768
.long 1088,64,360512,17408,1104,80,360528,17536
.long 1120,96,360544,17664,1136,112,360560,17792
.long 1152,128,361472,18432,1168,144,361488,18560
.long 1184,160,361504,18688,1200,176,361520,18816
.long 1216,192,361536,19456,1232,208,361552,19584
.long 1248,224,361568,19712,1264,240,361584,19840
.long 1280,256,362560,20480,1296,272,362576,20608
.long 1312,288,362592,20736,1328,304,362608,20864
.long 1344,320,362496,21504,1360,336,362512,21632
.long 1376,352,362528,21760,1392,368,362544,21888
.long 1408,384,363584,22528,1424,400,363600,22656
.long 1440,416,363616,22784,1456,432,363632,22912
.long 1472,448,363520,23552,1488,464,363536,23680
.long 1504,480,363552,23808,1520,496,363568,23936
.long 1536,512,364544,24576,1552,528,364560,24704
.long 1568,544,364576,24832,1584,560,364592,24960
.long 1600,576,364608,25600,1616,592,364624,25728
.long 1632,608,364640,25856,1648,624,364656,25984
.long 1664,640,365568,26624,1680,656,365584,26752
.long 1696,672,365600,26880,1712,688,365616,27008
.long 1728,704,365632,27648,1744,720,365648,27776
.long 1760,736,365664,27904,1776,752,365680,28032
.long 1792,768,366656,28672,1808,784,366672,28800
.long 1824,800,366688,28928,1840,816,366704,29056
.long 1856,832,366592,29696,1872,848,366608,29824
.long 1888,864,366624,29952,1904,880,366640,30080
.long 1920,896,367680,30720,1936,912,367696,30848
.long 1952,928,367712,30976,1968,944,367728,31104
.long 1984,960,367616,31744,2000,976,367632,31872
.long 2016,992,367648,32000,2032,1008,367664,32128
.long 0,1024,720896,32768,16,1040,720912,32896
.long 32,1056,720928,33024,48,1072,720944,33152
.long 64,1088,720960,33792,80,1104,720976,33920
.long 96,1120,720992,34048,112,1136,721008,34176
.long 128,1152,721920,34816,144,1168,721936,34944
.long 160,1184,721952,35072,176,1200,721968,35200
.long 192,1216,721984,35840,208,1232,722000,35968
.long 224,1248,722016,36096,240,1264,722032,36224
.long 256,1280,723008,36864,272,1296,723024,36992
.long 288,1312,723040,37120,304,1328,723056,37248
.long 320,1344,722944,37888,336,1360,722960,38016
.long 352,1376,722976,38144,368,1392,722992,38272
.long 384,1408,724032,38912,400,1424,724048,39040
.long 416,1440,724064,39168,432,1456,724080,39296
.long 448,1472,723968,39936,464,1488,723984,40064
.long 480,1504,724000,40192,496,1520,724016,40320
.long 512,1536,724992,40960,528,1552,725008,41088
.long 544,1568,725024,41216,560,1584,725040,41344
.long 576,1600,725056,41984,592,1616,725072,42112
.long 608,1632,725088,42240,624,1648,725104,42368
.long 640,1664,726016,43008,656,1680,726032,43136
.long 672,1696,726048,43264,688,1712,726064,43392
.long 704,1728,726080,1073741824,720,1744,726096,1073741824
.long 736,1760,726112,1073741824,752,1776,726128,1073741824
.long 768,1792,727104,1073741824,784,1808,727120,1073741824
.long 800,1824,727136,1073741824,816,1840,727152,1073741824
.long 832,1856,727040,1073741824,848,1872,727056,1073741824
.long 864,1888,727072,1073741824,880,1904,727088,1073741824
.long 896,1920,728128,1073741824,912,1936,728144,1073741824
.long 928,1952,728160,1073741824,944,1968,728176,1073741824
.long 960,1984,728064,1073741824,976,2000,728080,1073741824
.long 992,2016,728096,1073741824,1008,2032,728112,1073741824
.long 1024,0,1081344,1073741824,1040,16,1081360,1073741824
.long 1056,32,1081376,1073741824,1072,48,1081392,1073741824
.long 1088,64,1081408,1073741824,1104,80,1081424,1073741824
.long 1120,96,1081440,1073741824,1136,112,1081456,1073741824
.long 1152,128,1082368,1073741824,1168,144,1082384,1073741824
.long 1184,160,1082400,1073741824,1200,176,1082416,1073741824
.long 1216,192,1082432,1073741824,1232,208,1082448,1073741824
.long 1248,224,1082464,1073741824,1264,240,1082480,1073741824
.long 1280,256,1083456,1073741824,1296,272,1083472,1073741824
.long 1312,288,1083488,1073741824,1328,304,1083504,1073741824
.long 1344,320,1083392,1073741824,1360,336,1083408,1073741824
.long 1376,352,1083424,1073741824,1392,368,1083440,1073741824
.long 1408,384,1084480,1073741824,1424,400,1084496,1073741824
.long 1440,416,1084512,1073741824,1456,432,1084528,1073741824
.long 1472,448,1084416,1073741824,1488,464,1084432,1073741824
.long 1504,480,1084448,1073741824,1520,496,1084464,1073741824
.long 1536,512,1085440,1073741824,1552,528,1085456,1073741824
.long 1568,544,1085472,1073741824,1584,560,1085488,1073741824
.long 1600,576,1085504,1073741824,1616,592,1085520,1073741824
.long 1632,608,1085536,1073741824,1648,624,1085552,1073741824
.long 1664,640,1086464,1073741824,1680,656,1086480,1073741824
.long 1696,672,1086496,1073741824,1712,688,1086512,1073741824
.long 1728,704,1086528,1073741824,1744,720,1086544,1073741824
.long 1760,736,1086560,1073741824,1776,752,1086576,1073741824
.long 1792,768,1087552,1073741824,1808,784,1087568,1073741824
.long 1824,800,1087584,1073741824,1840,816,1087600,1073741824
.long 1856,832,1087488,1073741824,1872,848,1087504,1073741824
.long 1888,864,1087520,1073741824,1904,880,1087536,1073741824
.long 1920,896,1088576,1073741824,1936,912,1088592,1073741824
.long 1952,928,1088608,1073741824,1968,944,1088624,1073741824
.long 1984,960,1088512,1073741824,2000,976,1088528,1073741824
.long 2016,992,1088544,1073741824,2032,1008,1088560,1073741824
.long 0,15552,66784,0,16,15568,66800,8
.long 32,18240,66816,16,48,18256,66832,24
.long 64,18272,69504,96,80,18288,69520,104
.long 2752,18304,69536,112,2768,18320,69552,120
.long 2784,32000,69568,192,2800,32016,69584,200
.long 2816,32032,72256,208,2832,32048,72272,216
.long 5504,32064,72288,288,5520,32080,72304,296
.long 5536,34752,72320,304,5552,34768,72336,312
.long 5568,34784,52992,384,5584,34800,53008,392
.long 8256,34816,53024,400,8272,34832,53040,408
.long 8288,37504,53056,480,8304,37520,53072,488
.long 8320,37536,55744,496,8336,37552,55760,504
.long 22016,37568,55776,576,22032,37584,55792,584
.long 22048,40256,55808,592,22064,40272,55824,600
.long 22080,40288,58496,672,22096,40304,58512,680
.long 24768,40320,58528,688,24784,40336,58544,696
.long 24800,43008,58560,1536,24816,43024,58576,1544
.long 24832,43040,61248,1552,24848,43056,61264,1560
.long 27520,43072,61280,1632,27536,43088,61296,1640
.long 27552,45760,61312,1648,27568,45776,61328,1656
.long 27584,45792,75008,1728,27600,45808,75024,1736
.long 30272,45824,75040,1744,30288,45840,75056,1752
.long 30304,48512,75072,1824,30320,48528,75088,1832
.long 30336,48544,77760,1840,30352,48560,77776,1848
.long 11008,48576,77792,1920,11024,48592,77808,1928
.long 11040,51264,77824,1936,11056,51280,77840,1944
.long 11072,51296,80512,2016,11088,51312,80528,2024
.long 13760,51328,80544,2032,13776,51344,80560,2040
.long 13792,65024,80576,2112,13808,65040,80592,2120
.long 13824,65056,83264,2128,13840,65072,83280,2136
.long 16512,65088,83296,2208,16528,65104,83312,2216
.long 16544,67776,83328,2224,16560,67792,83344,2232
.long 96,15648,66880,20992,112,15664,66896,21000
.long 128,18336,66912,21008,144,18352,66928,21016
.long 160,18368,69600,21088,176,18384,69616,21096
.long 2848,18400,69632,21104,2864,18416,69648,21112
.long 2880,32096,69664,21184,2896,32112,69680,21192
.long 2912,32128,72352,21200,2928,32144,72368,21208
.long 5600,32160,72384,21280,5616,32176,72400,21288
.long 5632,34848,72416,21296,5648,34864,72432,21304
.long 5664,34880,53088,21376,5680,34896,53104,21384
.long 8352,34912,53120,21392,8368,34928,53136,21400
.long 8384,37600,53152,21472,8400,37616,53168,21480
.long 8416,37632,55840,21488,8432,37648,55856,21496
.long 22112,37664,55872,21568,22128,37680,55888,21576
.long 22144,40352,55904,21584,22160,40368,55920,21592
.long 22176,40384,58592,21664,22192,40400,58608,21672
.long 24864,40416,58624,21680,24880,40432,58640,21688
.long 24896,43104,58656,22528,24912,43120,58672,22536
.long 24928,43136,61344,22544,24944,43152,61360,22552
.long 27616,43168,61376,22624,27632,43184,61392,22632
.long 27648,45856,61408,22640,27664,45872,61424,22648
.long 27680,45888,75104,22720,27696,45904,75120,22728
.long 30368,45920,75136,22736,30384,45936,75152,22744
.long 30400,48608,75168,22816,30416,48624,75184,22824
.long 30432,48640,77856,22832,30448,48656,77872,22840
.long 11104,48672,77888,22912,11120,48688,77904,22920
.long 11136,51360,77920,22928,11152,51376,77936,22936
.long 11168,51392,80608,23008,11184,51408,80624,23016
.long 13856,51424,80640,23024,13872,51440,80656,23032
.long 13888,65120,80672,23104,13904,65136,80688,23112
.long 13920,65152,83360,23120,13936,65168,83376,23128
.long 16608,65184,83392,23200,16624,65200,83408,23208
.long 16640,67872,83424,23216,16656,67888,83440,23224
.long 192,15744,66976,41984,208,15760,66992,41992
.long 224,18432,67008,42000,240,18448,67024,42008
.long 256,18464,69696,42080,272,18480,69712,42088
.long 2944,18496,69728,42096,2960,18512,69744,42104
.long 2976,32192,69760,42176,2992,32208,69776,42184
.long 3008,32224,72448,42192,3024,32240,72464,42200
.long 5696,32256,72480,42272,5712,32272,72496,42280
.long 5728,34944,72512,42288,5744,34960,72528,42296
.long 5760,34976,53184,42368,5776,34992,53200,42376
.long 8448,35008,53216,42384,8464,35024,53232,42392
.long 8480,37696,53248,42464,8496,37712,53264,42472
.long 8512,37728,55936,42480,8528,37744,55952,42488
.long 22208,37760,55968,42560,22224,37776,55984,42568
.long 22240,40448,56000,42576,22256,40464,56016,42584
.long 22272,40480,58688,42656,22288,40496,58704,42664
.long 24960,40512,58720,42672,24976,40528,58736,42680
.long 24992,43200,58752,43520,25008,43216,58768,43528
.long 25024,43232,61440,43536,25040,43248,61456,43544
.long 27712,43264,61472,43616,27728,43280,61488,43624
.long 27744,45952,61504,43632,27760,45968,61520,43640
.long 27776,45984,75200,43712,27792,46000,75216,43720
.long 30464,46016,75232,43728,30480,46032,75248,43736
.long 30496,48704,75264,43808,30512,48720,75280,43816
.long 30528,48736,77952,43824,30544,48752,77968,43832
.long 11200,48768,77984,43904,11216,48784,78000,43912
.long 11232,51456,78016,43920,11248,51472,78032,43928
.long 11264,51488,80704,44000,11280,51504,80720,44008
.long 13952,51520,80736,44016,13968,51536,80752,44024
.long 13984,65216,80768,44096,14000,65232,80784,44104
.long 14016,65248,83456,44112,14032,65264,83472,44120
.long 16704,65280,83488,44192,16720,65296,83504,44200
.long 16736,67968,83520,44208,16752,67984,83536,44216
.long 288,1073741824,1073741824,62976,304,1073741824,1073741824,62984
.long 1073741824,18528,1073741824,62992,1073741824,18544,1073741824,63000
.long 1073741824,1073741824,69792,63072,1073741824,1073741824,69808,63080
.long 3040,1073741824,1073741824,63088,3056,1073741824,1073741824,63096
.long 1073741824,32288,1073741824,63168,1073741824,32304,1073741824,63176
.long 1073741824,1073741824,72544,63184,1073741824,1073741824,72560,63192
.long 5792,1073741824,1073741824,63264,5808,1073741824,1073741824,63272
.long 1073741824,35040,1073741824,63280,1073741824,35056,1073741824,63288
.long 1073741824,1073741824,53280,63360,1073741824,1073741824,53296,63368
.long 8544,1073741824,1073741824,63376,8560,1073741824,1073741824,63384
.long 1073741824,37792,1073741824,63456,1073741824,37808,1073741824,63464
.long 1073741824,1073741824,56032,63472,1073741824,1073741824,56048,63480
.long 22304,1073741824,1073741824,63552,22320,1073741824,1073741824,63560
.long 1073741824,40544,1073741824,63568,1073741824,40560,1073741824,63576
.long 1073741824,1073741824,58784,63648,1073741824,1073741824,58800,63656
.long 25056,1073741824,1073741824,63664,25072,1073741824,1073741824,63672
.long 1073741824,43296,1073741824,64512,1073741824,43312,1073741824,64520
.long 1073741824,1073741824,61536,64528,1073741824,1073741824,61552,64536
.long 27808,1073741824,1073741824,64608,27824,1073741824,1073741824,64616
.long 1073741824,46048,1073741824,64624,1073741824,46064,1073741824,64632
.long 1073741824,1073741824,75296,64704,1073741824,1073741824,75312,64712
.long 30560,1073741824,1073741824,64720,30576,1073741824,1073741824,64728
.long 1073741824,48800,1073741824,64800,1073741824,48816,1073741824,64808
.long 1073741824,1073741824,78048,64816,1073741824,1073741824,78064,64824
.long 11296,1073741824,1073741824,64896,11312,1073741824,1073741824,64904
.long 1073741824,51552,1073741824,64912,1073741824,51568,1073741824,64920
.long 1073741824,1073741824,80800,64992,1073741824,1073741824,80816,65000
.long 14048,1073741824,1073741824,65008,14064,1073741824,1073741824,65016
.long 1073741824,65312,1073741824,65088,1073741824,65328,1073741824,65096
.long 1073741824,1073741824,83552,65104,1073741824,1073741824,83568,65112
.long 16800,1073741824,1073741824,65184,16816,1073741824,1073741824,65192
.long 1073741824,68064,1073741824,65200,1073741824,68080,1073741824,65208
.size addr_table, 45056
.section .rodata,"a"
.p2align 6
.amdhsa_kernel recurrent_scan__ssm_conv_s4d__dense_activation_silu__prompt_kernel
  .amdhsa_next_free_vgpr 512
  .amdhsa_next_free_sgpr 102
  .amdhsa_accum_offset 256
  .amdhsa_group_segment_fixed_size 0
  .amdhsa_kernarg_size 104
  .amdhsa_user_sgpr_count 2
  .amdhsa_user_sgpr_kernarg_segment_ptr 1
  .amdhsa_system_sgpr_workgroup_id_x 1
.end_amdhsa_kernel
```
